```python
import torch

def _softmax(x, axis=-1):
    return torch.softmax(x, dim=axis)
def _gelu(x):
    return torch.nn.functional.gelu(x, approximate="tanh")
def _silu(x):
    return torch.nn.functional.silu(x)
def _sigmoid(x):
    return torch.sigmoid(x)
def _layernorm(x, axis=-1, eps=1e-5):
    m = x.mean(dim=axis, keepdim=True)
    v = x.var(dim=axis, keepdim=True, unbiased=False)
    return (x - m) / torch.sqrt(v + eps)
def _scatter_add(tgt, idx, src, axis=0):
    return tgt.clone().index_add_(axis, idx, src)
def _segment_sum(src, seg, n):
    out = torch.zeros((n,) + src.shape[1:], dtype=src.dtype)
    return out.index_add_(0, seg, src)
def _pad(x, pw):
    flat = tuple(v for pair in reversed(pw) for v in pair)
    return torch.nn.functional.pad(x, flat)

kernel_name = 'standalone__weight_only_int_squeezellm__prompt'

def setup_inputs():

    _w = (lambda a: (lambda t: t.to(torch.bfloat16) if t.is_floating_point() else t)(torch.as_tensor(a)))
    B, S, D, F = 1, 2048, 576, 4608
    bits = 8 if (2 <= 8 <= 4) else 4
    L = 2 ** bits
    qw = torch.randint(0, L, (D, F)).to(torch.int64)
    lut = (lambda *s: torch.randn(*s, dtype=torch.bfloat16) * 0.05)(L, F)
    return {
        "x": _w((lambda *s: torch.randn(*s, dtype=torch.bfloat16) * 0.05)(B, S, D)),
        "qw": _w(qw),
        "lut": _w(lut),
    }

def reference(x, qw, lut):
    w = (lambda x, i, axis: torch.take_along_dim(x, i, dim=axis))(lut, qw, axis=0)
    w = (lambda x, dt: x.to(dt))(w, x.dtype)
    return torch.einsum('bsd,df->bsf', x, w)
```

```asm
; @launch grid=(256,1,1) block=(768,1,1) lds=157696
.amdgcn_target "amdgcn-amd-amdhsa--gfx950"
.text
.globl standalone__weight_only_int_squeezellm__prompt_kernel
.p2align 8
.type standalone__weight_only_int_squeezellm__prompt_kernel,@function
standalone__weight_only_int_squeezellm__prompt_kernel:
    s_cmp_ge_u32 s2, 256
    s_cbranch_scc1 L_end
    s_and_b32 s3, s2, 7
    s_lshl_b32 s3, s3, 5
    s_lshr_b32 s4, s2, 3
    s_add_u32 s3, s3, s4
    s_cmp_ge_u32 s3, 252
    s_cbranch_scc1 L_end
    s_load_dwordx4 s[8:11], s[0:1], 0
    s_load_dwordx4 s[16:19], s[0:1], 16
    s_mul_i32 s47, s3, 9363
    s_lshr_b32 s47, s47, 16
    s_mul_i32 s5, s47, 7
    s_sub_u32 s49, s3, s5
    s_min_u32 s6, s49, 2
    s_mul_i32 s7, s49, 18
    s_add_u32 s7, s7, s6
    v_lshrrev_b32 v160, 6, v0
    v_and_b32 v0, 63, v0
    v_readfirstlane_b32 s30, v160
    v_and_b32 v160, 7, v0
    v_lshrrev_b32 v1, 3, v0
    v_lshrrev_b32 v161, 4, v0
    s_and_b32 s31, s30, 1
    s_lshl_b32 s31, s31, 2
    v_add_u32 v162, s31, v161
    v_xor_b32 v162, v162, v160
    v_mul_u32_u24 v1, 1152, v1
    v_lshl_add_u32 v1, v162, 4, v1
    s_and_b32 s34, s30, 7
    s_lshl_b32 s31, s7, 1
    s_add_u32 s31, s31, s34
    s_mul_i32 s25, s31, 9216
    s_lshl_b32 s35, s34, 10
    s_bfe_u32 s32, s30, 0x10001
    s_cmp_ge_u32 s30, 8
    s_cbranch_scc1 L_prod
    s_cmp_lt_u32 s49, 2
    s_mov_b32 s31, 0xD940E950
    s_cselect_b32 s31, 0xE940FA50, s31
    s_mov_b32 s48, 0xA5
    s_cselect_b32 s48, 0xE7, s48
    s_cselect_b32 s33, 6, 4
    s_lshl_b32 s34, s30, 2
    s_lshr_b32 s46, s31, s34
    s_and_b32 s46, s46, 15
    s_lshr_b32 s45, s48, s30
    s_and_b32 s45, s45, 1
    s_cmp_lt_u32 s30, s33
    s_cselect_b64 s[38:39], -1, 0
    s_lshr_b32 s33, s30, 2
    s_and_b32 s31, s30, 1
    s_mul_i32 s31, s31, 73728
    s_lshl_b32 s34, s47, 8
    s_add_u32 s31, s31, s34
    s_lshl_b32 s34, s33, 7
    s_add_u32 s31, s31, s34
    v_and_b32 v160, 31, v0
    v_xor_b32 v160, s32, v160
    v_lshrrev_b32 v162, 5, v0
    v_mul_u32_u24 v162, 9216, v162
    v_lshl_add_u32 v166, v160, 2, v162
    v_add_u32 v166, s31, v166
    s_waitcnt lgkmcnt(0)
    s_mov_b32 s20, s18
    s_and_b32 s21, s19, 0xffff
    s_and_b32 s17, s17, 0xffff
    s_mov_b32 s18, 147456
    s_mov_b32 s19, 0x20000
    s_mov_b32 s22, 18874368
    s_mov_b32 s23, 0x20000
    s_and_b32 s9, s9, 0xffff
    s_mov_b32 s10, 2359296
    s_mov_b32 s11, 0x20000
    s_add_u32 m0, s35, 149504
    s_mov_b32 s31, 0
    buffer_load_dword v166, s[16:19], s31 offen offset:0 lds
    s_mov_b32 s31, 18176
    buffer_load_dword v166, s[16:19], s31 offen offset:256 lds
    s_mov_b32 s31, 36352
    buffer_load_dword v166, s[16:19], s31 offen offset:512 lds
    s_mov_b32 s31, 54528
    buffer_load_dword v166, s[16:19], s31 offen offset:768 lds
    s_add_u32 m0, s35, 0
    s_nop 0
    buffer_load_dwordx4 v1, s[8:11], s25 offen  lds
    s_add_u32 s25, s25, 73728
    s_add_u32 m0, s35, 8192
    s_nop 0
    buffer_load_dwordx4 v1, s[8:11], s25 offen  lds
    s_add_u32 s25, s25, 73728
    s_add_u32 m0, s35, 16384
    s_nop 0
    buffer_load_dwordx4 v1, s[8:11], s25 offen  lds
    s_add_u32 s25, s25, 73728
    s_add_u32 m0, s35, 24576
    s_nop 0
    buffer_load_dwordx4 v1, s[8:11], s25 offen  lds
    s_add_u32 s25, s25, 73728
    s_add_u32 m0, s35, 32768
    s_mov_b64 exec, s[38:39]
    buffer_load_dwordx4 v1, s[8:11], s25 offen  lds
    s_mov_b64 exec, -1
    s_sub_u32 s25, s25, 294784
    v_and_b32 v160, 15, v0
    v_bfe_u32 v162, v0, 3, 1
    v_xor_b32 v2, v0, v162
    v_lshlrev_b32 v2, 4, v2
    s_lshl_b32 s31, s33, 12
    s_add_u32 s31, s31, 116736
    v_add_u32 v2, s31, v2
    v_lshrrev_b32 v162, 1, v160
    v_xor_b32 v162, v162, v161
    v_lshlrev_b32 v3, 7, v160
    v_lshl_add_u32 v3, v162, 4, v3
    s_lshl_b32 s31, s46, 11
    v_add_u32 v3, s31, v3
    v_xor_b32 v4, 64, v3
    v_add_u32 v5, 77824, v3
    v_add_u32 v6, 77824, v4
    v_and_b32 v7, 7, v0
    v_mul_u32_u24 v7, 9216, v7
    v_bfe_u32 v162, v0, 3, 1
    v_lshl_add_u32 v7, v162, 6, v7
    v_lshl_add_u32 v7, v161, 4, v7
    s_add_u32 s31, s7, s46
    s_mul_i32 s44, s31, 147456
    s_lshl_b32 s31, s47, 8
    s_add_u32 s44, s44, s31
    s_lshl_b32 s31, s33, 7
    s_add_u32 s44, s44, s31
    s_waitcnt vmcnt(4)
    s_barrier
    s_waitcnt vmcnt(0)
    s_cmp_eq_u32 s45, 0
    s_barrier
    ds_read_b128 v[24:27], v3 offset:0
    ds_read_b128 v[8:11], v2 offset:0
    ds_read_b128 v[12:15], v2 offset:1024
    ds_read_b128 v[16:19], v2 offset:2048
    ds_read_b128 v[20:23], v2 offset:3072
    ds_read_b128 v[28:31], v3 offset:2048
    ds_read_b128 v[32:35], v3 offset:4096
    ds_read_b128 v[36:39], v3 offset:6144
    ds_read_b128 v[40:43], v3 offset:8192
    s_waitcnt lgkmcnt(8)
    s_waitcnt lgkmcnt(7)
    v_mfma_f32_16x16x32_bf16 v[80:83], v[8:11], v[24:27], 0
    ds_read_b128 v[60:63], v4 offset:0
    s_waitcnt lgkmcnt(7)
    v_mfma_f32_16x16x32_bf16 v[84:87], v[12:15], v[24:27], 0
    ds_read_b128 v[44:47], v2 offset:8192
    s_waitcnt lgkmcnt(7)
    v_mfma_f32_16x16x32_bf16 v[88:91], v[16:19], v[24:27], 0
    ds_read_b128 v[48:51], v2 offset:9216
    s_waitcnt lgkmcnt(7)
    v_mfma_f32_16x16x32_bf16 v[92:95], v[20:23], v[24:27], 0
    ds_read_b128 v[52:55], v2 offset:10240
    s_waitcnt lgkmcnt(7)
    v_mfma_f32_16x16x32_bf16 v[96:99], v[8:11], v[28:31], 0
    ds_read_b128 v[56:59], v2 offset:11264
    v_mfma_f32_16x16x32_bf16 v[100:103], v[12:15], v[28:31], 0
    ds_read_b128 v[64:67], v4 offset:2048
    v_mfma_f32_16x16x32_bf16 v[104:107], v[16:19], v[28:31], 0
    ds_read_b128 v[68:71], v4 offset:4096
    v_mfma_f32_16x16x32_bf16 v[108:111], v[20:23], v[28:31], 0
    ds_read_b128 v[72:75], v4 offset:6144
    s_waitcnt lgkmcnt(10)
    v_mfma_f32_16x16x32_bf16 v[112:115], v[8:11], v[32:35], 0
    ds_read_b128 v[76:79], v4 offset:8192
    v_mfma_f32_16x16x32_bf16 v[116:119], v[12:15], v[32:35], 0
    v_mfma_f32_16x16x32_bf16 v[120:123], v[16:19], v[32:35], 0
    v_mfma_f32_16x16x32_bf16 v[124:127], v[20:23], v[32:35], 0
    s_waitcnt lgkmcnt(10)
    v_mfma_f32_16x16x32_bf16 v[128:131], v[8:11], v[36:39], 0
    v_mfma_f32_16x16x32_bf16 v[132:135], v[12:15], v[36:39], 0
    v_mfma_f32_16x16x32_bf16 v[136:139], v[16:19], v[36:39], 0
    v_mfma_f32_16x16x32_bf16 v[140:143], v[20:23], v[36:39], 0
    s_waitcnt lgkmcnt(9)
    s_cbranch_scc1 L_s1
    v_mfma_f32_16x16x32_bf16 v[144:147], v[8:11], v[40:43], 0
    v_mfma_f32_16x16x32_bf16 v[148:151], v[12:15], v[40:43], 0
    v_mfma_f32_16x16x32_bf16 v[152:155], v[16:19], v[40:43], 0
    v_mfma_f32_16x16x32_bf16 v[156:159], v[20:23], v[40:43], 0
L_s1:
    s_waitcnt lgkmcnt(0)
    s_barrier
    v_mfma_f32_16x16x32_bf16 v[80:83], v[44:47], v[60:63], v[80:83]
    ds_read_b128 v[24:27], v3 offset:38912
    v_mfma_f32_16x16x32_bf16 v[84:87], v[48:51], v[60:63], v[84:87]
    ds_read_b128 v[8:11], v2 offset:16384
    v_mfma_f32_16x16x32_bf16 v[88:91], v[52:55], v[60:63], v[88:91]
    ds_read_b128 v[12:15], v2 offset:17408
    v_mfma_f32_16x16x32_bf16 v[92:95], v[56:59], v[60:63], v[92:95]
    ds_read_b128 v[16:19], v2 offset:18432
    v_mfma_f32_16x16x32_bf16 v[96:99], v[44:47], v[64:67], v[96:99]
    ds_read_b128 v[20:23], v2 offset:19456
    v_mfma_f32_16x16x32_bf16 v[100:103], v[48:51], v[64:67], v[100:103]
    ds_read_b128 v[28:31], v3 offset:40960
    v_mfma_f32_16x16x32_bf16 v[104:107], v[52:55], v[64:67], v[104:107]
    ds_read_b128 v[32:35], v3 offset:43008
    v_mfma_f32_16x16x32_bf16 v[108:111], v[56:59], v[64:67], v[108:111]
    ds_read_b128 v[36:39], v3 offset:45056
    v_mfma_f32_16x16x32_bf16 v[112:115], v[44:47], v[68:71], v[112:115]
    ds_read_b128 v[40:43], v3 offset:47104
    v_mfma_f32_16x16x32_bf16 v[116:119], v[48:51], v[68:71], v[116:119]
    v_mfma_f32_16x16x32_bf16 v[120:123], v[52:55], v[68:71], v[120:123]
    v_mfma_f32_16x16x32_bf16 v[124:127], v[56:59], v[68:71], v[124:127]
    v_mfma_f32_16x16x32_bf16 v[128:131], v[44:47], v[72:75], v[128:131]
    v_mfma_f32_16x16x32_bf16 v[132:135], v[48:51], v[72:75], v[132:135]
    v_mfma_f32_16x16x32_bf16 v[136:139], v[52:55], v[72:75], v[136:139]
    v_mfma_f32_16x16x32_bf16 v[140:143], v[56:59], v[72:75], v[140:143]
    s_cbranch_scc1 L_s2
    v_mfma_f32_16x16x32_bf16 v[144:147], v[44:47], v[76:79], v[144:147]
    v_mfma_f32_16x16x32_bf16 v[148:151], v[48:51], v[76:79], v[148:151]
    v_mfma_f32_16x16x32_bf16 v[152:155], v[52:55], v[76:79], v[152:155]
    v_mfma_f32_16x16x32_bf16 v[156:159], v[56:59], v[76:79], v[156:159]
L_s2:
    s_waitcnt lgkmcnt(8)
    s_waitcnt lgkmcnt(7)
    v_mfma_f32_16x16x32_bf16 v[80:83], v[8:11], v[24:27], v[80:83]
    ds_read_b128 v[60:63], v4 offset:38912
    s_waitcnt lgkmcnt(7)
    v_mfma_f32_16x16x32_bf16 v[84:87], v[12:15], v[24:27], v[84:87]
    ds_read_b128 v[44:47], v2 offset:24576
    s_waitcnt lgkmcnt(7)
    v_mfma_f32_16x16x32_bf16 v[88:91], v[16:19], v[24:27], v[88:91]
    ds_read_b128 v[48:51], v2 offset:25600
    s_waitcnt lgkmcnt(7)
    v_mfma_f32_16x16x32_bf16 v[92:95], v[20:23], v[24:27], v[92:95]
    ds_read_b128 v[52:55], v2 offset:26624
    s_waitcnt lgkmcnt(7)
    v_mfma_f32_16x16x32_bf16 v[96:99], v[8:11], v[28:31], v[96:99]
    ds_read_b128 v[56:59], v2 offset:27648
    v_mfma_f32_16x16x32_bf16 v[100:103], v[12:15], v[28:31], v[100:103]
    ds_read_b128 v[64:67], v4 offset:40960
    v_mfma_f32_16x16x32_bf16 v[104:107], v[16:19], v[28:31], v[104:107]
    ds_read_b128 v[68:71], v4 offset:43008
    v_mfma_f32_16x16x32_bf16 v[108:111], v[20:23], v[28:31], v[108:111]
    ds_read_b128 v[72:75], v4 offset:45056
    s_waitcnt lgkmcnt(10)
    v_mfma_f32_16x16x32_bf16 v[112:115], v[8:11], v[32:35], v[112:115]
    ds_read_b128 v[76:79], v4 offset:47104
    v_mfma_f32_16x16x32_bf16 v[116:119], v[12:15], v[32:35], v[116:119]
    v_mfma_f32_16x16x32_bf16 v[120:123], v[16:19], v[32:35], v[120:123]
    v_mfma_f32_16x16x32_bf16 v[124:127], v[20:23], v[32:35], v[124:127]
    s_waitcnt lgkmcnt(10)
    v_mfma_f32_16x16x32_bf16 v[128:131], v[8:11], v[36:39], v[128:131]
    v_mfma_f32_16x16x32_bf16 v[132:135], v[12:15], v[36:39], v[132:135]
    v_mfma_f32_16x16x32_bf16 v[136:139], v[16:19], v[36:39], v[136:139]
    v_mfma_f32_16x16x32_bf16 v[140:143], v[20:23], v[36:39], v[140:143]
    s_waitcnt lgkmcnt(9)
    s_cbranch_scc1 L_s3
    v_mfma_f32_16x16x32_bf16 v[144:147], v[8:11], v[40:43], v[144:147]
    v_mfma_f32_16x16x32_bf16 v[148:151], v[12:15], v[40:43], v[148:151]
    v_mfma_f32_16x16x32_bf16 v[152:155], v[16:19], v[40:43], v[152:155]
    v_mfma_f32_16x16x32_bf16 v[156:159], v[20:23], v[40:43], v[156:159]
L_s3:
    s_waitcnt lgkmcnt(0)
    s_barrier
    v_mfma_f32_16x16x32_bf16 v[80:83], v[44:47], v[60:63], v[80:83]
    ds_read_b128 v[24:27], v5 offset:0
    v_mfma_f32_16x16x32_bf16 v[84:87], v[48:51], v[60:63], v[84:87]
    ds_read_b128 v[8:11], v2 offset:0
    v_mfma_f32_16x16x32_bf16 v[88:91], v[52:55], v[60:63], v[88:91]
    ds_read_b128 v[12:15], v2 offset:1024
    v_mfma_f32_16x16x32_bf16 v[92:95], v[56:59], v[60:63], v[92:95]
    ds_read_b128 v[16:19], v2 offset:2048
    v_mfma_f32_16x16x32_bf16 v[96:99], v[44:47], v[64:67], v[96:99]
    ds_read_b128 v[20:23], v2 offset:3072
    v_mfma_f32_16x16x32_bf16 v[100:103], v[48:51], v[64:67], v[100:103]
    ds_read_b128 v[28:31], v5 offset:2048
    v_mfma_f32_16x16x32_bf16 v[104:107], v[52:55], v[64:67], v[104:107]
    ds_read_b128 v[32:35], v5 offset:4096
    v_mfma_f32_16x16x32_bf16 v[108:111], v[56:59], v[64:67], v[108:111]
    ds_read_b128 v[36:39], v5 offset:6144
    v_mfma_f32_16x16x32_bf16 v[112:115], v[44:47], v[68:71], v[112:115]
    ds_read_b128 v[40:43], v5 offset:8192
    v_mfma_f32_16x16x32_bf16 v[116:119], v[48:51], v[68:71], v[116:119]
    v_mfma_f32_16x16x32_bf16 v[120:123], v[52:55], v[68:71], v[120:123]
    v_mfma_f32_16x16x32_bf16 v[124:127], v[56:59], v[68:71], v[124:127]
    v_mfma_f32_16x16x32_bf16 v[128:131], v[44:47], v[72:75], v[128:131]
    v_mfma_f32_16x16x32_bf16 v[132:135], v[48:51], v[72:75], v[132:135]
    v_mfma_f32_16x16x32_bf16 v[136:139], v[52:55], v[72:75], v[136:139]
    v_mfma_f32_16x16x32_bf16 v[140:143], v[56:59], v[72:75], v[140:143]
    s_cbranch_scc1 L_s4
    v_mfma_f32_16x16x32_bf16 v[144:147], v[44:47], v[76:79], v[144:147]
    v_mfma_f32_16x16x32_bf16 v[148:151], v[48:51], v[76:79], v[148:151]
    v_mfma_f32_16x16x32_bf16 v[152:155], v[52:55], v[76:79], v[152:155]
    v_mfma_f32_16x16x32_bf16 v[156:159], v[56:59], v[76:79], v[156:159]
L_s4:
    s_waitcnt lgkmcnt(8)
    s_waitcnt lgkmcnt(7)
    v_mfma_f32_16x16x32_bf16 v[80:83], v[8:11], v[24:27], v[80:83]
    ds_read_b128 v[60:63], v6 offset:0
    s_waitcnt lgkmcnt(7)
    v_mfma_f32_16x16x32_bf16 v[84:87], v[12:15], v[24:27], v[84:87]
    ds_read_b128 v[44:47], v2 offset:8192
    s_waitcnt lgkmcnt(7)
    v_mfma_f32_16x16x32_bf16 v[88:91], v[16:19], v[24:27], v[88:91]
    ds_read_b128 v[48:51], v2 offset:9216
    s_waitcnt lgkmcnt(7)
    v_mfma_f32_16x16x32_bf16 v[92:95], v[20:23], v[24:27], v[92:95]
    ds_read_b128 v[52:55], v2 offset:10240
    s_waitcnt lgkmcnt(7)
    v_mfma_f32_16x16x32_bf16 v[96:99], v[8:11], v[28:31], v[96:99]
    ds_read_b128 v[56:59], v2 offset:11264
    v_mfma_f32_16x16x32_bf16 v[100:103], v[12:15], v[28:31], v[100:103]
    ds_read_b128 v[64:67], v6 offset:2048
    v_mfma_f32_16x16x32_bf16 v[104:107], v[16:19], v[28:31], v[104:107]
    ds_read_b128 v[68:71], v6 offset:4096
    v_mfma_f32_16x16x32_bf16 v[108:111], v[20:23], v[28:31], v[108:111]
    ds_read_b128 v[72:75], v6 offset:6144
    s_waitcnt lgkmcnt(10)
    v_mfma_f32_16x16x32_bf16 v[112:115], v[8:11], v[32:35], v[112:115]
    ds_read_b128 v[76:79], v6 offset:8192
    v_mfma_f32_16x16x32_bf16 v[116:119], v[12:15], v[32:35], v[116:119]
    v_mfma_f32_16x16x32_bf16 v[120:123], v[16:19], v[32:35], v[120:123]
    v_mfma_f32_16x16x32_bf16 v[124:127], v[20:23], v[32:35], v[124:127]
    s_waitcnt lgkmcnt(10)
    v_mfma_f32_16x16x32_bf16 v[128:131], v[8:11], v[36:39], v[128:131]
    v_mfma_f32_16x16x32_bf16 v[132:135], v[12:15], v[36:39], v[132:135]
    v_mfma_f32_16x16x32_bf16 v[136:139], v[16:19], v[36:39], v[136:139]
    v_mfma_f32_16x16x32_bf16 v[140:143], v[20:23], v[36:39], v[140:143]
    s_waitcnt lgkmcnt(9)
    s_cbranch_scc1 L_s5
    v_mfma_f32_16x16x32_bf16 v[144:147], v[8:11], v[40:43], v[144:147]
    v_mfma_f32_16x16x32_bf16 v[148:151], v[12:15], v[40:43], v[148:151]
    v_mfma_f32_16x16x32_bf16 v[152:155], v[16:19], v[40:43], v[152:155]
    v_mfma_f32_16x16x32_bf16 v[156:159], v[20:23], v[40:43], v[156:159]
L_s5:
    s_waitcnt lgkmcnt(0)
    s_barrier
    v_mfma_f32_16x16x32_bf16 v[80:83], v[44:47], v[60:63], v[80:83]
    ds_read_b128 v[24:27], v3 offset:0
    v_mfma_f32_16x16x32_bf16 v[84:87], v[48:51], v[60:63], v[84:87]
    ds_read_b128 v[8:11], v2 offset:16384
    v_mfma_f32_16x16x32_bf16 v[88:91], v[52:55], v[60:63], v[88:91]
    ds_read_b128 v[12:15], v2 offset:17408
    v_mfma_f32_16x16x32_bf16 v[92:95], v[56:59], v[60:63], v[92:95]
    ds_read_b128 v[16:19], v2 offset:18432
    v_mfma_f32_16x16x32_bf16 v[96:99], v[44:47], v[64:67], v[96:99]
    ds_read_b128 v[20:23], v2 offset:19456
    v_mfma_f32_16x16x32_bf16 v[100:103], v[48:51], v[64:67], v[100:103]
    ds_read_b128 v[28:31], v3 offset:2048
    v_mfma_f32_16x16x32_bf16 v[104:107], v[52:55], v[64:67], v[104:107]
    ds_read_b128 v[32:35], v3 offset:4096
    v_mfma_f32_16x16x32_bf16 v[108:111], v[56:59], v[64:67], v[108:111]
    ds_read_b128 v[36:39], v3 offset:6144
    v_mfma_f32_16x16x32_bf16 v[112:115], v[44:47], v[68:71], v[112:115]
    ds_read_b128 v[40:43], v3 offset:8192
    v_mfma_f32_16x16x32_bf16 v[116:119], v[48:51], v[68:71], v[116:119]
    v_mfma_f32_16x16x32_bf16 v[120:123], v[52:55], v[68:71], v[120:123]
    v_mfma_f32_16x16x32_bf16 v[124:127], v[56:59], v[68:71], v[124:127]
    v_mfma_f32_16x16x32_bf16 v[128:131], v[44:47], v[72:75], v[128:131]
    v_mfma_f32_16x16x32_bf16 v[132:135], v[48:51], v[72:75], v[132:135]
    v_mfma_f32_16x16x32_bf16 v[136:139], v[52:55], v[72:75], v[136:139]
    v_mfma_f32_16x16x32_bf16 v[140:143], v[56:59], v[72:75], v[140:143]
    s_cbranch_scc1 L_s6
    v_mfma_f32_16x16x32_bf16 v[144:147], v[44:47], v[76:79], v[144:147]
    v_mfma_f32_16x16x32_bf16 v[148:151], v[48:51], v[76:79], v[148:151]
    v_mfma_f32_16x16x32_bf16 v[152:155], v[52:55], v[76:79], v[152:155]
    v_mfma_f32_16x16x32_bf16 v[156:159], v[56:59], v[76:79], v[156:159]
L_s6:
    s_waitcnt lgkmcnt(8)
    s_waitcnt lgkmcnt(7)
    v_mfma_f32_16x16x32_bf16 v[80:83], v[8:11], v[24:27], v[80:83]
    ds_read_b128 v[60:63], v4 offset:0
    s_waitcnt lgkmcnt(7)
    v_mfma_f32_16x16x32_bf16 v[84:87], v[12:15], v[24:27], v[84:87]
    ds_read_b128 v[44:47], v2 offset:24576
    s_waitcnt lgkmcnt(7)
    v_mfma_f32_16x16x32_bf16 v[88:91], v[16:19], v[24:27], v[88:91]
    ds_read_b128 v[48:51], v2 offset:25600
    s_waitcnt lgkmcnt(7)
    v_mfma_f32_16x16x32_bf16 v[92:95], v[20:23], v[24:27], v[92:95]
    ds_read_b128 v[52:55], v2 offset:26624
    s_waitcnt lgkmcnt(7)
    v_mfma_f32_16x16x32_bf16 v[96:99], v[8:11], v[28:31], v[96:99]
    ds_read_b128 v[56:59], v2 offset:27648
    v_mfma_f32_16x16x32_bf16 v[100:103], v[12:15], v[28:31], v[100:103]
    ds_read_b128 v[64:67], v4 offset:2048
    v_mfma_f32_16x16x32_bf16 v[104:107], v[16:19], v[28:31], v[104:107]
    ds_read_b128 v[68:71], v4 offset:4096
    v_mfma_f32_16x16x32_bf16 v[108:111], v[20:23], v[28:31], v[108:111]
    ds_read_b128 v[72:75], v4 offset:6144
    s_waitcnt lgkmcnt(10)
    v_mfma_f32_16x16x32_bf16 v[112:115], v[8:11], v[32:35], v[112:115]
    ds_read_b128 v[76:79], v4 offset:8192
    v_mfma_f32_16x16x32_bf16 v[116:119], v[12:15], v[32:35], v[116:119]
    v_mfma_f32_16x16x32_bf16 v[120:123], v[16:19], v[32:35], v[120:123]
    v_mfma_f32_16x16x32_bf16 v[124:127], v[20:23], v[32:35], v[124:127]
    s_waitcnt lgkmcnt(10)
    v_mfma_f32_16x16x32_bf16 v[128:131], v[8:11], v[36:39], v[128:131]
    v_mfma_f32_16x16x32_bf16 v[132:135], v[12:15], v[36:39], v[132:135]
    v_mfma_f32_16x16x32_bf16 v[136:139], v[16:19], v[36:39], v[136:139]
    v_mfma_f32_16x16x32_bf16 v[140:143], v[20:23], v[36:39], v[140:143]
    s_waitcnt lgkmcnt(9)
    s_cbranch_scc1 L_s7
    v_mfma_f32_16x16x32_bf16 v[144:147], v[8:11], v[40:43], v[144:147]
    v_mfma_f32_16x16x32_bf16 v[148:151], v[12:15], v[40:43], v[148:151]
    v_mfma_f32_16x16x32_bf16 v[152:155], v[16:19], v[40:43], v[152:155]
    v_mfma_f32_16x16x32_bf16 v[156:159], v[20:23], v[40:43], v[156:159]
L_s7:
    s_waitcnt lgkmcnt(0)
    s_barrier
    v_mfma_f32_16x16x32_bf16 v[80:83], v[44:47], v[60:63], v[80:83]
    ds_read_b128 v[24:27], v3 offset:38912
    v_mfma_f32_16x16x32_bf16 v[84:87], v[48:51], v[60:63], v[84:87]
    ds_read_b128 v[8:11], v2 offset:0
    v_mfma_f32_16x16x32_bf16 v[88:91], v[52:55], v[60:63], v[88:91]
    ds_read_b128 v[12:15], v2 offset:1024
    v_mfma_f32_16x16x32_bf16 v[92:95], v[56:59], v[60:63], v[92:95]
    ds_read_b128 v[16:19], v2 offset:2048
    v_mfma_f32_16x16x32_bf16 v[96:99], v[44:47], v[64:67], v[96:99]
    ds_read_b128 v[20:23], v2 offset:3072
    v_mfma_f32_16x16x32_bf16 v[100:103], v[48:51], v[64:67], v[100:103]
    ds_read_b128 v[28:31], v3 offset:40960
    v_mfma_f32_16x16x32_bf16 v[104:107], v[52:55], v[64:67], v[104:107]
    ds_read_b128 v[32:35], v3 offset:43008
    v_mfma_f32_16x16x32_bf16 v[108:111], v[56:59], v[64:67], v[108:111]
    ds_read_b128 v[36:39], v3 offset:45056
    v_mfma_f32_16x16x32_bf16 v[112:115], v[44:47], v[68:71], v[112:115]
    ds_read_b128 v[40:43], v3 offset:47104
    v_mfma_f32_16x16x32_bf16 v[116:119], v[48:51], v[68:71], v[116:119]
    v_mfma_f32_16x16x32_bf16 v[120:123], v[52:55], v[68:71], v[120:123]
    v_mfma_f32_16x16x32_bf16 v[124:127], v[56:59], v[68:71], v[124:127]
    v_mfma_f32_16x16x32_bf16 v[128:131], v[44:47], v[72:75], v[128:131]
    v_mfma_f32_16x16x32_bf16 v[132:135], v[48:51], v[72:75], v[132:135]
    v_mfma_f32_16x16x32_bf16 v[136:139], v[52:55], v[72:75], v[136:139]
    v_mfma_f32_16x16x32_bf16 v[140:143], v[56:59], v[72:75], v[140:143]
    s_cbranch_scc1 L_s8
    v_mfma_f32_16x16x32_bf16 v[144:147], v[44:47], v[76:79], v[144:147]
    v_mfma_f32_16x16x32_bf16 v[148:151], v[48:51], v[76:79], v[148:151]
    v_mfma_f32_16x16x32_bf16 v[152:155], v[52:55], v[76:79], v[152:155]
    v_mfma_f32_16x16x32_bf16 v[156:159], v[56:59], v[76:79], v[156:159]
L_s8:
    s_waitcnt lgkmcnt(8)
    s_waitcnt lgkmcnt(7)
    v_mfma_f32_16x16x32_bf16 v[80:83], v[8:11], v[24:27], v[80:83]
    ds_read_b128 v[60:63], v4 offset:38912
    s_waitcnt lgkmcnt(7)
    v_mfma_f32_16x16x32_bf16 v[84:87], v[12:15], v[24:27], v[84:87]
    ds_read_b128 v[44:47], v2 offset:8192
    s_waitcnt lgkmcnt(7)
    v_mfma_f32_16x16x32_bf16 v[88:91], v[16:19], v[24:27], v[88:91]
    ds_read_b128 v[48:51], v2 offset:9216
    s_waitcnt lgkmcnt(7)
    v_mfma_f32_16x16x32_bf16 v[92:95], v[20:23], v[24:27], v[92:95]
    ds_read_b128 v[52:55], v2 offset:10240
    s_waitcnt lgkmcnt(7)
    v_mfma_f32_16x16x32_bf16 v[96:99], v[8:11], v[28:31], v[96:99]
    ds_read_b128 v[56:59], v2 offset:11264
    v_mfma_f32_16x16x32_bf16 v[100:103], v[12:15], v[28:31], v[100:103]
    ds_read_b128 v[64:67], v4 offset:40960
    v_mfma_f32_16x16x32_bf16 v[104:107], v[16:19], v[28:31], v[104:107]
    ds_read_b128 v[68:71], v4 offset:43008
    v_mfma_f32_16x16x32_bf16 v[108:111], v[20:23], v[28:31], v[108:111]
    ds_read_b128 v[72:75], v4 offset:45056
    s_waitcnt lgkmcnt(10)
    v_mfma_f32_16x16x32_bf16 v[112:115], v[8:11], v[32:35], v[112:115]
    ds_read_b128 v[76:79], v4 offset:47104
    v_mfma_f32_16x16x32_bf16 v[116:119], v[12:15], v[32:35], v[116:119]
    v_mfma_f32_16x16x32_bf16 v[120:123], v[16:19], v[32:35], v[120:123]
    v_mfma_f32_16x16x32_bf16 v[124:127], v[20:23], v[32:35], v[124:127]
    s_waitcnt lgkmcnt(10)
    v_mfma_f32_16x16x32_bf16 v[128:131], v[8:11], v[36:39], v[128:131]
    v_mfma_f32_16x16x32_bf16 v[132:135], v[12:15], v[36:39], v[132:135]
    v_mfma_f32_16x16x32_bf16 v[136:139], v[16:19], v[36:39], v[136:139]
    v_mfma_f32_16x16x32_bf16 v[140:143], v[20:23], v[36:39], v[140:143]
    s_waitcnt lgkmcnt(9)
    s_cbranch_scc1 L_s9
    v_mfma_f32_16x16x32_bf16 v[144:147], v[8:11], v[40:43], v[144:147]
    v_mfma_f32_16x16x32_bf16 v[148:151], v[12:15], v[40:43], v[148:151]
    v_mfma_f32_16x16x32_bf16 v[152:155], v[16:19], v[40:43], v[152:155]
    v_mfma_f32_16x16x32_bf16 v[156:159], v[20:23], v[40:43], v[156:159]
L_s9:
    s_waitcnt lgkmcnt(0)
    s_barrier
    v_mfma_f32_16x16x32_bf16 v[80:83], v[44:47], v[60:63], v[80:83]
    ds_read_b128 v[24:27], v5 offset:0
    v_mfma_f32_16x16x32_bf16 v[84:87], v[48:51], v[60:63], v[84:87]
    ds_read_b128 v[8:11], v2 offset:16384
    v_mfma_f32_16x16x32_bf16 v[88:91], v[52:55], v[60:63], v[88:91]
    ds_read_b128 v[12:15], v2 offset:17408
    v_mfma_f32_16x16x32_bf16 v[92:95], v[56:59], v[60:63], v[92:95]
    ds_read_b128 v[16:19], v2 offset:18432
    v_mfma_f32_16x16x32_bf16 v[96:99], v[44:47], v[64:67], v[96:99]
    ds_read_b128 v[20:23], v2 offset:19456
    v_mfma_f32_16x16x32_bf16 v[100:103], v[48:51], v[64:67], v[100:103]
    ds_read_b128 v[28:31], v5 offset:2048
    v_mfma_f32_16x16x32_bf16 v[104:107], v[52:55], v[64:67], v[104:107]
    ds_read_b128 v[32:35], v5 offset:4096
    v_mfma_f32_16x16x32_bf16 v[108:111], v[56:59], v[64:67], v[108:111]
    ds_read_b128 v[36:39], v5 offset:6144
    v_mfma_f32_16x16x32_bf16 v[112:115], v[44:47], v[68:71], v[112:115]
    ds_read_b128 v[40:43], v5 offset:8192
    v_mfma_f32_16x16x32_bf16 v[116:119], v[48:51], v[68:71], v[116:119]
    v_mfma_f32_16x16x32_bf16 v[120:123], v[52:55], v[68:71], v[120:123]
    v_mfma_f32_16x16x32_bf16 v[124:127], v[56:59], v[68:71], v[124:127]
    v_mfma_f32_16x16x32_bf16 v[128:131], v[44:47], v[72:75], v[128:131]
    v_mfma_f32_16x16x32_bf16 v[132:135], v[48:51], v[72:75], v[132:135]
    v_mfma_f32_16x16x32_bf16 v[136:139], v[52:55], v[72:75], v[136:139]
    v_mfma_f32_16x16x32_bf16 v[140:143], v[56:59], v[72:75], v[140:143]
    s_cbranch_scc1 L_s10
    v_mfma_f32_16x16x32_bf16 v[144:147], v[44:47], v[76:79], v[144:147]
    v_mfma_f32_16x16x32_bf16 v[148:151], v[48:51], v[76:79], v[148:151]
    v_mfma_f32_16x16x32_bf16 v[152:155], v[52:55], v[76:79], v[152:155]
    v_mfma_f32_16x16x32_bf16 v[156:159], v[56:59], v[76:79], v[156:159]
L_s10:
    s_waitcnt lgkmcnt(8)
    s_waitcnt lgkmcnt(7)
    v_mfma_f32_16x16x32_bf16 v[80:83], v[8:11], v[24:27], v[80:83]
    ds_read_b128 v[60:63], v6 offset:0
    s_waitcnt lgkmcnt(7)
    v_mfma_f32_16x16x32_bf16 v[84:87], v[12:15], v[24:27], v[84:87]
    ds_read_b128 v[44:47], v2 offset:24576
    s_waitcnt lgkmcnt(7)
    v_mfma_f32_16x16x32_bf16 v[88:91], v[16:19], v[24:27], v[88:91]
    ds_read_b128 v[48:51], v2 offset:25600
    s_waitcnt lgkmcnt(7)
    v_mfma_f32_16x16x32_bf16 v[92:95], v[20:23], v[24:27], v[92:95]
    ds_read_b128 v[52:55], v2 offset:26624
    s_waitcnt lgkmcnt(7)
    v_mfma_f32_16x16x32_bf16 v[96:99], v[8:11], v[28:31], v[96:99]
    ds_read_b128 v[56:59], v2 offset:27648
    v_mfma_f32_16x16x32_bf16 v[100:103], v[12:15], v[28:31], v[100:103]
    ds_read_b128 v[64:67], v6 offset:2048
    v_mfma_f32_16x16x32_bf16 v[104:107], v[16:19], v[28:31], v[104:107]
    ds_read_b128 v[68:71], v6 offset:4096
    v_mfma_f32_16x16x32_bf16 v[108:111], v[20:23], v[28:31], v[108:111]
    ds_read_b128 v[72:75], v6 offset:6144
    s_waitcnt lgkmcnt(10)
    v_mfma_f32_16x16x32_bf16 v[112:115], v[8:11], v[32:35], v[112:115]
    ds_read_b128 v[76:79], v6 offset:8192
    v_mfma_f32_16x16x32_bf16 v[116:119], v[12:15], v[32:35], v[116:119]
    v_mfma_f32_16x16x32_bf16 v[120:123], v[16:19], v[32:35], v[120:123]
    v_mfma_f32_16x16x32_bf16 v[124:127], v[20:23], v[32:35], v[124:127]
    s_waitcnt lgkmcnt(10)
    v_mfma_f32_16x16x32_bf16 v[128:131], v[8:11], v[36:39], v[128:131]
    v_mfma_f32_16x16x32_bf16 v[132:135], v[12:15], v[36:39], v[132:135]
    v_mfma_f32_16x16x32_bf16 v[136:139], v[16:19], v[36:39], v[136:139]
    v_mfma_f32_16x16x32_bf16 v[140:143], v[20:23], v[36:39], v[140:143]
    s_waitcnt lgkmcnt(9)
    s_cbranch_scc1 L_s11
    v_mfma_f32_16x16x32_bf16 v[144:147], v[8:11], v[40:43], v[144:147]
    v_mfma_f32_16x16x32_bf16 v[148:151], v[12:15], v[40:43], v[148:151]
    v_mfma_f32_16x16x32_bf16 v[152:155], v[16:19], v[40:43], v[152:155]
    v_mfma_f32_16x16x32_bf16 v[156:159], v[20:23], v[40:43], v[156:159]
L_s11:
    s_waitcnt lgkmcnt(0)
    s_barrier
    v_mfma_f32_16x16x32_bf16 v[80:83], v[44:47], v[60:63], v[80:83]
    ds_read_b128 v[24:27], v3 offset:0
    v_mfma_f32_16x16x32_bf16 v[84:87], v[48:51], v[60:63], v[84:87]
    ds_read_b128 v[8:11], v2 offset:0
    v_mfma_f32_16x16x32_bf16 v[88:91], v[52:55], v[60:63], v[88:91]
    ds_read_b128 v[12:15], v2 offset:1024
    v_mfma_f32_16x16x32_bf16 v[92:95], v[56:59], v[60:63], v[92:95]
    ds_read_b128 v[16:19], v2 offset:2048
    v_mfma_f32_16x16x32_bf16 v[96:99], v[44:47], v[64:67], v[96:99]
    ds_read_b128 v[20:23], v2 offset:3072
    v_mfma_f32_16x16x32_bf16 v[100:103], v[48:51], v[64:67], v[100:103]
    ds_read_b128 v[28:31], v3 offset:2048
    v_mfma_f32_16x16x32_bf16 v[104:107], v[52:55], v[64:67], v[104:107]
    ds_read_b128 v[32:35], v3 offset:4096
    v_mfma_f32_16x16x32_bf16 v[108:111], v[56:59], v[64:67], v[108:111]
    ds_read_b128 v[36:39], v3 offset:6144
    v_mfma_f32_16x16x32_bf16 v[112:115], v[44:47], v[68:71], v[112:115]
    ds_read_b128 v[40:43], v3 offset:8192
    v_mfma_f32_16x16x32_bf16 v[116:119], v[48:51], v[68:71], v[116:119]
    v_mfma_f32_16x16x32_bf16 v[120:123], v[52:55], v[68:71], v[120:123]
    v_mfma_f32_16x16x32_bf16 v[124:127], v[56:59], v[68:71], v[124:127]
    v_mfma_f32_16x16x32_bf16 v[128:131], v[44:47], v[72:75], v[128:131]
    v_mfma_f32_16x16x32_bf16 v[132:135], v[48:51], v[72:75], v[132:135]
    v_mfma_f32_16x16x32_bf16 v[136:139], v[52:55], v[72:75], v[136:139]
    v_mfma_f32_16x16x32_bf16 v[140:143], v[56:59], v[72:75], v[140:143]
    s_cbranch_scc1 L_s12
    v_mfma_f32_16x16x32_bf16 v[144:147], v[44:47], v[76:79], v[144:147]
    v_mfma_f32_16x16x32_bf16 v[148:151], v[48:51], v[76:79], v[148:151]
    v_mfma_f32_16x16x32_bf16 v[152:155], v[52:55], v[76:79], v[152:155]
    v_mfma_f32_16x16x32_bf16 v[156:159], v[56:59], v[76:79], v[156:159]
L_s12:
    s_waitcnt lgkmcnt(8)
    s_waitcnt lgkmcnt(7)
    v_mfma_f32_16x16x32_bf16 v[80:83], v[8:11], v[24:27], v[80:83]
    ds_read_b128 v[60:63], v4 offset:0
    s_waitcnt lgkmcnt(7)
    v_mfma_f32_16x16x32_bf16 v[84:87], v[12:15], v[24:27], v[84:87]
    ds_read_b128 v[44:47], v2 offset:8192
    s_waitcnt lgkmcnt(7)
    v_mfma_f32_16x16x32_bf16 v[88:91], v[16:19], v[24:27], v[88:91]
    ds_read_b128 v[48:51], v2 offset:9216
    s_waitcnt lgkmcnt(7)
    v_mfma_f32_16x16x32_bf16 v[92:95], v[20:23], v[24:27], v[92:95]
    ds_read_b128 v[52:55], v2 offset:10240
    s_waitcnt lgkmcnt(7)
    v_mfma_f32_16x16x32_bf16 v[96:99], v[8:11], v[28:31], v[96:99]
    ds_read_b128 v[56:59], v2 offset:11264
    v_mfma_f32_16x16x32_bf16 v[100:103], v[12:15], v[28:31], v[100:103]
    ds_read_b128 v[64:67], v4 offset:2048
    v_mfma_f32_16x16x32_bf16 v[104:107], v[16:19], v[28:31], v[104:107]
    ds_read_b128 v[68:71], v4 offset:4096
    v_mfma_f32_16x16x32_bf16 v[108:111], v[20:23], v[28:31], v[108:111]
    ds_read_b128 v[72:75], v4 offset:6144
    s_waitcnt lgkmcnt(10)
    v_mfma_f32_16x16x32_bf16 v[112:115], v[8:11], v[32:35], v[112:115]
    ds_read_b128 v[76:79], v4 offset:8192
    v_mfma_f32_16x16x32_bf16 v[116:119], v[12:15], v[32:35], v[116:119]
    v_mfma_f32_16x16x32_bf16 v[120:123], v[16:19], v[32:35], v[120:123]
    v_mfma_f32_16x16x32_bf16 v[124:127], v[20:23], v[32:35], v[124:127]
    s_waitcnt lgkmcnt(10)
    v_mfma_f32_16x16x32_bf16 v[128:131], v[8:11], v[36:39], v[128:131]
    v_mfma_f32_16x16x32_bf16 v[132:135], v[12:15], v[36:39], v[132:135]
    v_mfma_f32_16x16x32_bf16 v[136:139], v[16:19], v[36:39], v[136:139]
    v_mfma_f32_16x16x32_bf16 v[140:143], v[20:23], v[36:39], v[140:143]
    s_waitcnt lgkmcnt(9)
    s_cbranch_scc1 L_s13
    v_mfma_f32_16x16x32_bf16 v[144:147], v[8:11], v[40:43], v[144:147]
    v_mfma_f32_16x16x32_bf16 v[148:151], v[12:15], v[40:43], v[148:151]
    v_mfma_f32_16x16x32_bf16 v[152:155], v[16:19], v[40:43], v[152:155]
    v_mfma_f32_16x16x32_bf16 v[156:159], v[20:23], v[40:43], v[156:159]
L_s13:
    s_waitcnt lgkmcnt(0)
    s_barrier
    v_mfma_f32_16x16x32_bf16 v[80:83], v[44:47], v[60:63], v[80:83]
    ds_read_b128 v[24:27], v3 offset:38912
    v_mfma_f32_16x16x32_bf16 v[84:87], v[48:51], v[60:63], v[84:87]
    ds_read_b128 v[8:11], v2 offset:16384
    v_mfma_f32_16x16x32_bf16 v[88:91], v[52:55], v[60:63], v[88:91]
    ds_read_b128 v[12:15], v2 offset:17408
    v_mfma_f32_16x16x32_bf16 v[92:95], v[56:59], v[60:63], v[92:95]
    ds_read_b128 v[16:19], v2 offset:18432
    v_mfma_f32_16x16x32_bf16 v[96:99], v[44:47], v[64:67], v[96:99]
    ds_read_b128 v[20:23], v2 offset:19456
    v_mfma_f32_16x16x32_bf16 v[100:103], v[48:51], v[64:67], v[100:103]
    ds_read_b128 v[28:31], v3 offset:40960
    v_mfma_f32_16x16x32_bf16 v[104:107], v[52:55], v[64:67], v[104:107]
    ds_read_b128 v[32:35], v3 offset:43008
    v_mfma_f32_16x16x32_bf16 v[108:111], v[56:59], v[64:67], v[108:111]
    ds_read_b128 v[36:39], v3 offset:45056
    v_mfma_f32_16x16x32_bf16 v[112:115], v[44:47], v[68:71], v[112:115]
    ds_read_b128 v[40:43], v3 offset:47104
    v_mfma_f32_16x16x32_bf16 v[116:119], v[48:51], v[68:71], v[116:119]
    v_mfma_f32_16x16x32_bf16 v[120:123], v[52:55], v[68:71], v[120:123]
    v_mfma_f32_16x16x32_bf16 v[124:127], v[56:59], v[68:71], v[124:127]
    v_mfma_f32_16x16x32_bf16 v[128:131], v[44:47], v[72:75], v[128:131]
    v_mfma_f32_16x16x32_bf16 v[132:135], v[48:51], v[72:75], v[132:135]
    v_mfma_f32_16x16x32_bf16 v[136:139], v[52:55], v[72:75], v[136:139]
    v_mfma_f32_16x16x32_bf16 v[140:143], v[56:59], v[72:75], v[140:143]
    s_cbranch_scc1 L_s14
    v_mfma_f32_16x16x32_bf16 v[144:147], v[44:47], v[76:79], v[144:147]
    v_mfma_f32_16x16x32_bf16 v[148:151], v[48:51], v[76:79], v[148:151]
    v_mfma_f32_16x16x32_bf16 v[152:155], v[52:55], v[76:79], v[152:155]
    v_mfma_f32_16x16x32_bf16 v[156:159], v[56:59], v[76:79], v[156:159]
L_s14:
    s_waitcnt lgkmcnt(8)
    s_waitcnt lgkmcnt(7)
    v_mfma_f32_16x16x32_bf16 v[80:83], v[8:11], v[24:27], v[80:83]
    ds_read_b128 v[60:63], v4 offset:38912
    s_waitcnt lgkmcnt(7)
    v_mfma_f32_16x16x32_bf16 v[84:87], v[12:15], v[24:27], v[84:87]
    ds_read_b128 v[44:47], v2 offset:24576
    s_waitcnt lgkmcnt(7)
    v_mfma_f32_16x16x32_bf16 v[88:91], v[16:19], v[24:27], v[88:91]
    ds_read_b128 v[48:51], v2 offset:25600
    s_waitcnt lgkmcnt(7)
    v_mfma_f32_16x16x32_bf16 v[92:95], v[20:23], v[24:27], v[92:95]
    ds_read_b128 v[52:55], v2 offset:26624
    s_waitcnt lgkmcnt(7)
    v_mfma_f32_16x16x32_bf16 v[96:99], v[8:11], v[28:31], v[96:99]
    ds_read_b128 v[56:59], v2 offset:27648
    v_mfma_f32_16x16x32_bf16 v[100:103], v[12:15], v[28:31], v[100:103]
    ds_read_b128 v[64:67], v4 offset:40960
    v_mfma_f32_16x16x32_bf16 v[104:107], v[16:19], v[28:31], v[104:107]
    ds_read_b128 v[68:71], v4 offset:43008
    v_mfma_f32_16x16x32_bf16 v[108:111], v[20:23], v[28:31], v[108:111]
    ds_read_b128 v[72:75], v4 offset:45056
    s_waitcnt lgkmcnt(10)
    v_mfma_f32_16x16x32_bf16 v[112:115], v[8:11], v[32:35], v[112:115]
    ds_read_b128 v[76:79], v4 offset:47104
    v_mfma_f32_16x16x32_bf16 v[116:119], v[12:15], v[32:35], v[116:119]
    v_mfma_f32_16x16x32_bf16 v[120:123], v[16:19], v[32:35], v[120:123]
    v_mfma_f32_16x16x32_bf16 v[124:127], v[20:23], v[32:35], v[124:127]
    s_waitcnt lgkmcnt(10)
    v_mfma_f32_16x16x32_bf16 v[128:131], v[8:11], v[36:39], v[128:131]
    v_mfma_f32_16x16x32_bf16 v[132:135], v[12:15], v[36:39], v[132:135]
    v_mfma_f32_16x16x32_bf16 v[136:139], v[16:19], v[36:39], v[136:139]
    v_mfma_f32_16x16x32_bf16 v[140:143], v[20:23], v[36:39], v[140:143]
    s_waitcnt lgkmcnt(9)
    s_cbranch_scc1 L_s15
    v_mfma_f32_16x16x32_bf16 v[144:147], v[8:11], v[40:43], v[144:147]
    v_mfma_f32_16x16x32_bf16 v[148:151], v[12:15], v[40:43], v[148:151]
    v_mfma_f32_16x16x32_bf16 v[152:155], v[16:19], v[40:43], v[152:155]
    v_mfma_f32_16x16x32_bf16 v[156:159], v[20:23], v[40:43], v[156:159]
L_s15:
    s_waitcnt lgkmcnt(0)
    s_barrier
    v_mov_b32 v4, v2
    ds_read_b128 v[24:27], v5 offset:0
    ds_read_b128 v[8:11], v4 offset:0
    v_mfma_f32_16x16x32_bf16 v[80:83], v[44:47], v[60:63], v[80:83]
    ds_read_b128 v[12:15], v4 offset:1024
    ds_read_b128 v[16:19], v4 offset:2048
    v_mfma_f32_16x16x32_bf16 v[84:87], v[48:51], v[60:63], v[84:87]
    ds_read_b128 v[20:23], v4 offset:3072
    ds_read_b128 v[160:163], v4 offset:10240
    v_mfma_f32_16x16x32_bf16 v[88:91], v[52:55], v[60:63], v[88:91]
    ds_read_b128 v[164:167], v4 offset:11264
    ds_read_b128 v[0:3], v6 offset:0
    v_mfma_f32_16x16x32_bf16 v[92:95], v[56:59], v[60:63], v[92:95]
    v_mfma_f32_16x16x32_bf16 v[96:99], v[44:47], v[64:67], v[96:99]
    ds_read_b128 v[60:63], v4 offset:8192
    v_mfma_f32_16x16x32_bf16 v[100:103], v[48:51], v[64:67], v[100:103]
    ds_read_b128 v[28:31], v5 offset:2048
    v_mfma_f32_16x16x32_bf16 v[104:107], v[52:55], v[64:67], v[104:107]
    ds_read_b128 v[32:35], v5 offset:4096
    v_mfma_f32_16x16x32_bf16 v[108:111], v[56:59], v[64:67], v[108:111]
    ds_read_b128 v[36:39], v5 offset:6144
    ds_read_b128 v[64:67], v4 offset:9216
    s_waitcnt lgkmcnt(12)
    s_waitcnt lgkmcnt(11)
    v_mfma_f32_16x16x32_bf16 v[80:83], v[8:11], v[24:27], v[80:83]
    ds_read_b128 v[40:43], v5 offset:8192
    s_waitcnt lgkmcnt(11)
    v_mfma_f32_16x16x32_bf16 v[84:87], v[12:15], v[24:27], v[84:87]
    s_waitcnt lgkmcnt(10)
    v_mfma_f32_16x16x32_bf16 v[88:91], v[16:19], v[24:27], v[88:91]
    s_waitcnt lgkmcnt(9)
    v_mfma_f32_16x16x32_bf16 v[92:95], v[20:23], v[24:27], v[92:95]
    ds_read_b128 v[24:27], v6 offset:2048
    s_waitcnt lgkmcnt(7)
    v_mfma_f32_16x16x32_bf16 v[88:91], v[160:163], v[0:3], v[88:91]
    v_mfma_f32_16x16x32_bf16 v[92:95], v[164:167], v[0:3], v[92:95]
    s_waitcnt lgkmcnt(6)
    v_mfma_f32_16x16x32_bf16 v[80:83], v[60:63], v[0:3], v[80:83]
    s_waitcnt lgkmcnt(2)
    v_mfma_f32_16x16x32_bf16 v[84:87], v[64:67], v[0:3], v[84:87]
    ds_read_b128 v[0:3], v6 offset:6144
    v_mfma_f32_16x16x32_bf16 v[96:99], v[8:11], v[28:31], v[96:99]
    v_mfma_f32_16x16x32_bf16 v[100:103], v[12:15], v[28:31], v[100:103]
    v_mfma_f32_16x16x32_bf16 v[104:107], v[16:19], v[28:31], v[104:107]
    v_mfma_f32_16x16x32_bf16 v[108:111], v[20:23], v[28:31], v[108:111]
    ds_read_b128 v[28:31], v6 offset:4096
    v_cvt_pk_bf16_f32 v80, v80, v84
    v_cvt_pk_bf16_f32 v81, v81, v85
    v_cvt_pk_bf16_f32 v82, v82, v86
    v_cvt_pk_bf16_f32 v83, v83, v87
    v_cvt_pk_bf16_f32 v88, v88, v92
    v_cvt_pk_bf16_f32 v89, v89, v93
    v_cvt_pk_bf16_f32 v90, v90, v94
    v_cvt_pk_bf16_f32 v91, v91, v95
    v_mov_b32 v84, v80
    v_mov_b32 v85, v81
    v_mov_b32 v86, v82
    v_mov_b32 v87, v83
    v_mov_b32_dpp v80, v88 row_ror:8 row_mask:0xf bank_mask:0xc
    v_mov_b32_dpp v81, v89 row_ror:8 row_mask:0xf bank_mask:0xc
    v_mov_b32_dpp v82, v90 row_ror:8 row_mask:0xf bank_mask:0xc
    v_mov_b32_dpp v83, v91 row_ror:8 row_mask:0xf bank_mask:0xc
    v_mov_b32_dpp v88, v84 row_ror:8 row_mask:0xf bank_mask:0x3
    v_mov_b32_dpp v89, v85 row_ror:8 row_mask:0xf bank_mask:0x3
    v_mov_b32_dpp v90, v86 row_ror:8 row_mask:0xf bank_mask:0x3
    v_mov_b32_dpp v91, v87 row_ror:8 row_mask:0xf bank_mask:0x3
    buffer_store_dwordx4 v[80:83], v7, s[20:23], s44 offen sc0 sc1
    s_add_u32 s44, s44, 73728
    buffer_store_dwordx4 v[88:91], v7, s[20:23], s44 offen sc0 sc1
    s_add_u32 s44, s44, 73728
    s_waitcnt lgkmcnt(2)
    v_mfma_f32_16x16x32_bf16 v[96:99], v[60:63], v[24:27], v[96:99]
    v_mfma_f32_16x16x32_bf16 v[100:103], v[64:67], v[24:27], v[100:103]
    v_mfma_f32_16x16x32_bf16 v[104:107], v[160:163], v[24:27], v[104:107]
    v_mfma_f32_16x16x32_bf16 v[108:111], v[164:167], v[24:27], v[108:111]
    ds_read_b128 v[24:27], v6 offset:8192
    v_mfma_f32_16x16x32_bf16 v[112:115], v[44:47], v[68:71], v[112:115]
    v_mfma_f32_16x16x32_bf16 v[116:119], v[48:51], v[68:71], v[116:119]
    v_mfma_f32_16x16x32_bf16 v[120:123], v[52:55], v[68:71], v[120:123]
    v_mfma_f32_16x16x32_bf16 v[124:127], v[56:59], v[68:71], v[124:127]
    v_cvt_pk_bf16_f32 v96, v96, v100
    v_cvt_pk_bf16_f32 v97, v97, v101
    v_cvt_pk_bf16_f32 v98, v98, v102
    v_cvt_pk_bf16_f32 v99, v99, v103
    v_cvt_pk_bf16_f32 v104, v104, v108
    v_cvt_pk_bf16_f32 v105, v105, v109
    v_cvt_pk_bf16_f32 v106, v106, v110
    v_cvt_pk_bf16_f32 v107, v107, v111
    v_mov_b32 v100, v96
    v_mov_b32 v101, v97
    v_mov_b32 v102, v98
    v_mov_b32 v103, v99
    v_mov_b32_dpp v96, v104 row_ror:8 row_mask:0xf bank_mask:0xc
    v_mov_b32_dpp v97, v105 row_ror:8 row_mask:0xf bank_mask:0xc
    v_mov_b32_dpp v98, v106 row_ror:8 row_mask:0xf bank_mask:0xc
    v_mov_b32_dpp v99, v107 row_ror:8 row_mask:0xf bank_mask:0xc
    v_mov_b32_dpp v104, v100 row_ror:8 row_mask:0xf bank_mask:0x3
    v_mov_b32_dpp v105, v101 row_ror:8 row_mask:0xf bank_mask:0x3
    v_mov_b32_dpp v106, v102 row_ror:8 row_mask:0xf bank_mask:0x3
    v_mov_b32_dpp v107, v103 row_ror:8 row_mask:0xf bank_mask:0x3
    buffer_store_dwordx4 v[96:99], v7, s[20:23], s44 offen sc0 sc1
    s_add_u32 s44, s44, 73728
    buffer_store_dwordx4 v[104:107], v7, s[20:23], s44 offen sc0 sc1
    s_add_u32 s44, s44, 73728
    v_mfma_f32_16x16x32_bf16 v[112:115], v[8:11], v[32:35], v[112:115]
    v_mfma_f32_16x16x32_bf16 v[116:119], v[12:15], v[32:35], v[116:119]
    v_mfma_f32_16x16x32_bf16 v[120:123], v[16:19], v[32:35], v[120:123]
    v_mfma_f32_16x16x32_bf16 v[124:127], v[20:23], v[32:35], v[124:127]
    s_waitcnt lgkmcnt(1)
    v_mfma_f32_16x16x32_bf16 v[112:115], v[60:63], v[28:31], v[112:115]
    v_mfma_f32_16x16x32_bf16 v[116:119], v[64:67], v[28:31], v[116:119]
    v_mfma_f32_16x16x32_bf16 v[120:123], v[160:163], v[28:31], v[120:123]
    v_mfma_f32_16x16x32_bf16 v[124:127], v[164:167], v[28:31], v[124:127]
    v_mfma_f32_16x16x32_bf16 v[128:131], v[44:47], v[72:75], v[128:131]
    v_mfma_f32_16x16x32_bf16 v[132:135], v[48:51], v[72:75], v[132:135]
    v_mfma_f32_16x16x32_bf16 v[136:139], v[52:55], v[72:75], v[136:139]
    v_mfma_f32_16x16x32_bf16 v[140:143], v[56:59], v[72:75], v[140:143]
    v_cvt_pk_bf16_f32 v112, v112, v116
    v_cvt_pk_bf16_f32 v113, v113, v117
    v_cvt_pk_bf16_f32 v114, v114, v118
    v_cvt_pk_bf16_f32 v115, v115, v119
    v_cvt_pk_bf16_f32 v120, v120, v124
    v_cvt_pk_bf16_f32 v121, v121, v125
    v_cvt_pk_bf16_f32 v122, v122, v126
    v_cvt_pk_bf16_f32 v123, v123, v127
    v_mov_b32 v116, v112
    v_mov_b32 v117, v113
    v_mov_b32 v118, v114
    v_mov_b32 v119, v115
    v_mov_b32_dpp v112, v120 row_ror:8 row_mask:0xf bank_mask:0xc
    v_mov_b32_dpp v113, v121 row_ror:8 row_mask:0xf bank_mask:0xc
    v_mov_b32_dpp v114, v122 row_ror:8 row_mask:0xf bank_mask:0xc
    v_mov_b32_dpp v115, v123 row_ror:8 row_mask:0xf bank_mask:0xc
    v_mov_b32_dpp v120, v116 row_ror:8 row_mask:0xf bank_mask:0x3
    v_mov_b32_dpp v121, v117 row_ror:8 row_mask:0xf bank_mask:0x3
    v_mov_b32_dpp v122, v118 row_ror:8 row_mask:0xf bank_mask:0x3
    v_mov_b32_dpp v123, v119 row_ror:8 row_mask:0xf bank_mask:0x3
    buffer_store_dwordx4 v[112:115], v7, s[20:23], s44 offen sc0 sc1
    s_add_u32 s44, s44, 73728
    buffer_store_dwordx4 v[120:123], v7, s[20:23], s44 offen sc0 sc1
    s_add_u32 s44, s44, 73728
    v_mfma_f32_16x16x32_bf16 v[128:131], v[8:11], v[36:39], v[128:131]
    v_mfma_f32_16x16x32_bf16 v[132:135], v[12:15], v[36:39], v[132:135]
    v_mfma_f32_16x16x32_bf16 v[136:139], v[16:19], v[36:39], v[136:139]
    v_mfma_f32_16x16x32_bf16 v[140:143], v[20:23], v[36:39], v[140:143]
    v_mfma_f32_16x16x32_bf16 v[128:131], v[60:63], v[0:3], v[128:131]
    v_mfma_f32_16x16x32_bf16 v[132:135], v[64:67], v[0:3], v[132:135]
    v_mfma_f32_16x16x32_bf16 v[136:139], v[160:163], v[0:3], v[136:139]
    v_mfma_f32_16x16x32_bf16 v[140:143], v[164:167], v[0:3], v[140:143]
    s_waitcnt lgkmcnt(0)
    s_cmp_eq_u32 s45, 0
    s_cbranch_scc1 L_four
    v_mfma_f32_16x16x32_bf16 v[144:147], v[44:47], v[76:79], v[144:147]
    v_mfma_f32_16x16x32_bf16 v[148:151], v[48:51], v[76:79], v[148:151]
    v_mfma_f32_16x16x32_bf16 v[152:155], v[52:55], v[76:79], v[152:155]
    v_mfma_f32_16x16x32_bf16 v[156:159], v[56:59], v[76:79], v[156:159]
    v_cvt_pk_bf16_f32 v128, v128, v132
    v_cvt_pk_bf16_f32 v129, v129, v133
    v_cvt_pk_bf16_f32 v130, v130, v134
    v_cvt_pk_bf16_f32 v131, v131, v135
    v_cvt_pk_bf16_f32 v136, v136, v140
    v_cvt_pk_bf16_f32 v137, v137, v141
    v_cvt_pk_bf16_f32 v138, v138, v142
    v_cvt_pk_bf16_f32 v139, v139, v143
    v_mov_b32 v132, v128
    v_mov_b32 v133, v129
    v_mov_b32 v134, v130
    v_mov_b32 v135, v131
    v_mov_b32_dpp v128, v136 row_ror:8 row_mask:0xf bank_mask:0xc
    v_mov_b32_dpp v129, v137 row_ror:8 row_mask:0xf bank_mask:0xc
    v_mov_b32_dpp v130, v138 row_ror:8 row_mask:0xf bank_mask:0xc
    v_mov_b32_dpp v131, v139 row_ror:8 row_mask:0xf bank_mask:0xc
    v_mov_b32_dpp v136, v132 row_ror:8 row_mask:0xf bank_mask:0x3
    v_mov_b32_dpp v137, v133 row_ror:8 row_mask:0xf bank_mask:0x3
    v_mov_b32_dpp v138, v134 row_ror:8 row_mask:0xf bank_mask:0x3
    v_mov_b32_dpp v139, v135 row_ror:8 row_mask:0xf bank_mask:0x3
    buffer_store_dwordx4 v[128:131], v7, s[20:23], s44 offen sc0 sc1
    s_add_u32 s44, s44, 73728
    buffer_store_dwordx4 v[136:139], v7, s[20:23], s44 offen sc0 sc1
    s_add_u32 s44, s44, 73728
    v_mfma_f32_16x16x32_bf16 v[144:147], v[8:11], v[40:43], v[144:147]
    v_mfma_f32_16x16x32_bf16 v[148:151], v[12:15], v[40:43], v[148:151]
    v_mfma_f32_16x16x32_bf16 v[152:155], v[16:19], v[40:43], v[152:155]
    v_mfma_f32_16x16x32_bf16 v[156:159], v[20:23], v[40:43], v[156:159]
    v_mfma_f32_16x16x32_bf16 v[144:147], v[60:63], v[24:27], v[144:147]
    v_mfma_f32_16x16x32_bf16 v[148:151], v[64:67], v[24:27], v[148:151]
    v_mfma_f32_16x16x32_bf16 v[152:155], v[160:163], v[24:27], v[152:155]
    v_mfma_f32_16x16x32_bf16 v[156:159], v[164:167], v[24:27], v[156:159]
    s_nop 7
    s_nop 3
    v_cvt_pk_bf16_f32 v144, v144, v148
    v_cvt_pk_bf16_f32 v145, v145, v149
    v_cvt_pk_bf16_f32 v146, v146, v150
    v_cvt_pk_bf16_f32 v147, v147, v151
    v_cvt_pk_bf16_f32 v152, v152, v156
    v_cvt_pk_bf16_f32 v153, v153, v157
    v_cvt_pk_bf16_f32 v154, v154, v158
    v_cvt_pk_bf16_f32 v155, v155, v159
    v_mov_b32 v148, v144
    v_mov_b32 v149, v145
    v_mov_b32 v150, v146
    v_mov_b32 v151, v147
    v_mov_b32_dpp v144, v152 row_ror:8 row_mask:0xf bank_mask:0xc
    v_mov_b32_dpp v145, v153 row_ror:8 row_mask:0xf bank_mask:0xc
    v_mov_b32_dpp v146, v154 row_ror:8 row_mask:0xf bank_mask:0xc
    v_mov_b32_dpp v147, v155 row_ror:8 row_mask:0xf bank_mask:0xc
    v_mov_b32_dpp v152, v148 row_ror:8 row_mask:0xf bank_mask:0x3
    v_mov_b32_dpp v153, v149 row_ror:8 row_mask:0xf bank_mask:0x3
    v_mov_b32_dpp v154, v150 row_ror:8 row_mask:0xf bank_mask:0x3
    v_mov_b32_dpp v155, v151 row_ror:8 row_mask:0xf bank_mask:0x3
    buffer_store_dwordx4 v[144:147], v7, s[20:23], s44 offen sc0 sc1
    s_add_u32 s44, s44, 73728
    buffer_store_dwordx4 v[152:155], v7, s[20:23], s44 offen sc0 sc1
    s_add_u32 s44, s44, 73728
    s_endpgm
L_four:
    s_nop 7
    s_nop 3
    v_cvt_pk_bf16_f32 v128, v128, v132
    v_cvt_pk_bf16_f32 v129, v129, v133
    v_cvt_pk_bf16_f32 v130, v130, v134
    v_cvt_pk_bf16_f32 v131, v131, v135
    v_cvt_pk_bf16_f32 v136, v136, v140
    v_cvt_pk_bf16_f32 v137, v137, v141
    v_cvt_pk_bf16_f32 v138, v138, v142
    v_cvt_pk_bf16_f32 v139, v139, v143
    v_mov_b32 v132, v128
    v_mov_b32 v133, v129
    v_mov_b32 v134, v130
    v_mov_b32 v135, v131
    v_mov_b32_dpp v128, v136 row_ror:8 row_mask:0xf bank_mask:0xc
    v_mov_b32_dpp v129, v137 row_ror:8 row_mask:0xf bank_mask:0xc
    v_mov_b32_dpp v130, v138 row_ror:8 row_mask:0xf bank_mask:0xc
    v_mov_b32_dpp v131, v139 row_ror:8 row_mask:0xf bank_mask:0xc
    v_mov_b32_dpp v136, v132 row_ror:8 row_mask:0xf bank_mask:0x3
    v_mov_b32_dpp v137, v133 row_ror:8 row_mask:0xf bank_mask:0x3
    v_mov_b32_dpp v138, v134 row_ror:8 row_mask:0xf bank_mask:0x3
    v_mov_b32_dpp v139, v135 row_ror:8 row_mask:0xf bank_mask:0x3
    buffer_store_dwordx4 v[128:131], v7, s[20:23], s44 offen sc0 sc1
    s_add_u32 s44, s44, 73728
    buffer_store_dwordx4 v[136:139], v7, s[20:23], s44 offen sc0 sc1
    s_add_u32 s44, s44, 73728
    s_endpgm
L_prod:
    v_and_b32 v164, 15, v0
    v_mul_u32_u24 v2, 147456, v161
    v_lshl_add_u32 v2, v164, 4, v2
    s_and_b32 s33, s30, 1
    s_mul_i32 s31, s33, 589824
    s_lshl_b32 s34, s47, 9
    s_add_u32 s31, s31, s34
    s_lshl_b32 s34, s32, 8
    s_add_u32 s24, s31, s34
    s_add_u32 s25, s25, 128
    s_cmp_lt_u32 s49, 2
    s_cselect_b32 s31, 10, 8
    s_cmp_lt_u32 s30, s31
    s_cselect_b64 s[38:39], -1, 0
    s_mov_b32 s36, 0x05040100
    s_mov_b32 s37, 0x07060302
    s_waitcnt lgkmcnt(0)
    s_mov_b32 s12, s10
    s_and_b32 s13, s11, 0xffff
    s_mov_b32 s14, 10616832
    s_mov_b32 s15, 0x20000
    s_and_b32 s9, s9, 0xffff
    s_mov_b32 s10, 2359296
    s_mov_b32 s11, 0x20000
    buffer_load_dwordx4 v[24:27], v2, s[12:15], s24 offen
    s_add_u32 s24, s24, 18432
    buffer_load_dwordx4 v[28:31], v2, s[12:15], s24 offen
    s_add_u32 s24, s24, 18432
    buffer_load_dwordx4 v[32:35], v2, s[12:15], s24 offen
    s_add_u32 s24, s24, 18432
    buffer_load_dwordx4 v[36:39], v2, s[12:15], s24 offen
    s_add_u32 s24, s24, 18432
    buffer_load_dwordx4 v[40:43], v2, s[12:15], s24 offen
    s_add_u32 s24, s24, 18432
    buffer_load_dwordx4 v[44:47], v2, s[12:15], s24 offen
    s_add_u32 s24, s24, 18432
    buffer_load_dwordx4 v[48:51], v2, s[12:15], s24 offen
    s_add_u32 s24, s24, 18432
    buffer_load_dwordx4 v[52:55], v2, s[12:15], s24 offen
    s_add_u32 s24, s24, 1050624
    v_and_b32 v162, 1, v161
    s_lshl_b32 s31, s32, 12
    s_add_u32 s31, s31, 149504
    v_lshl_add_u32 v3, v164, 1, v162
    v_lshlrev_b32 v3, 2, v3
    v_lshl_add_u32 v3, v162, 11, v3
    v_add_u32 v3, s31, v3
    v_xor_b32 v4, 4, v3
    v_lshrrev_b32 v5, 2, v160
    v_lshl_add_u32 v5, v160, 1, v5
    v_lshlrev_b32 v5, 4, v5
    v_lshl_add_u32 v5, v161, 8, v5
    v_bfe_u32 v162, v0, 3, 1
    v_lshl_add_u32 v5, v162, 11, v5
    s_lshl_b32 s31, s33, 13
    s_lshl_b32 s34, s32, 12
    s_add_u32 s31, s31, s34
    s_add_u32 s31, s31, 116736
    v_add_u32 v5, s31, v5
    v_xor_b32 v6, 16, v5
    buffer_load_dwordx4 v[56:59], v2, s[12:15], s24 offen
    s_add_u32 s24, s24, 18432
    buffer_load_dwordx4 v[60:63], v2, s[12:15], s24 offen
    s_add_u32 s24, s24, 18432
    buffer_load_dwordx4 v[64:67], v2, s[12:15], s24 offen
    s_add_u32 s24, s24, 18432
    buffer_load_dwordx4 v[68:71], v2, s[12:15], s24 offen
    s_add_u32 s24, s24, 18432
    buffer_load_dwordx4 v[72:75], v2, s[12:15], s24 offen
    s_add_u32 s24, s24, 18432
    buffer_load_dwordx4 v[76:79], v2, s[12:15], s24 offen
    s_add_u32 s24, s24, 18432
    buffer_load_dwordx4 v[80:83], v2, s[12:15], s24 offen
    s_add_u32 s24, s24, 18432
    buffer_load_dwordx4 v[84:87], v2, s[12:15], s24 offen
    s_add_u32 s24, s24, 1050624
    s_barrier
    s_add_u32 m0, s35, 38912
    s_nop 0
    buffer_load_dwordx4 v1, s[8:11], s25 offen  lds
    s_add_u32 s25, s25, 36864
    s_waitcnt vmcnt(15)
    v_lshl_add_u32 v24, v24, 7, v3
    ds_read_b32 v24, v24
    v_lshl_add_u32 v25, v25, 7, v3
    ds_read_b32 v25, v25
    v_lshl_add_u32 v26, v26, 7, v4
    ds_read_b32 v26, v26
    s_add_u32 m0, s35, 43008
    s_nop 0
    buffer_load_dwordx4 v1, s[8:11], s25 offen  lds
    s_add_u32 s25, s25, 36864
    v_lshl_add_u32 v27, v27, 7, v4
    ds_read_b32 v27, v27
    v_lshl_add_u32 v28, v28, 7, v3
    ds_read_b32 v28, v28
    v_lshl_add_u32 v29, v29, 7, v3
    ds_read_b32 v29, v29
    s_add_u32 m0, s35, 47104
    s_nop 0
    buffer_load_dwordx4 v1, s[8:11], s25 offen  lds
    s_add_u32 s25, s25, 36864
    v_lshl_add_u32 v30, v30, 7, v4
    ds_read_b32 v30, v30
    v_lshl_add_u32 v31, v31, 7, v4
    ds_read_b32 v31, v31
    s_add_u32 m0, s35, 51200
    s_nop 0
    buffer_load_dwordx4 v1, s[8:11], s25 offen  lds
    s_add_u32 s25, s25, 36864
    s_waitcnt vmcnt(16)
    v_lshl_add_u32 v32, v32, 7, v3
    ds_read_b32 v32, v32
    v_lshl_add_u32 v33, v33, 7, v3
    ds_read_b32 v33, v33
    v_lshl_add_u32 v34, v34, 7, v4
    ds_read_b32 v34, v34
    s_add_u32 m0, s35, 55296
    s_nop 0
    buffer_load_dwordx4 v1, s[8:11], s25 offen  lds
    s_add_u32 s25, s25, 36864
    v_lshl_add_u32 v35, v35, 7, v4
    ds_read_b32 v35, v35
    v_lshl_add_u32 v36, v36, 7, v3
    ds_read_b32 v36, v36
    v_lshl_add_u32 v37, v37, 7, v3
    ds_read_b32 v37, v37
    s_add_u32 m0, s35, 59392
    s_nop 0
    buffer_load_dwordx4 v1, s[8:11], s25 offen  lds
    s_add_u32 s25, s25, 36864
    v_lshl_add_u32 v38, v38, 7, v4
    ds_read_b32 v38, v38
    v_lshl_add_u32 v39, v39, 7, v4
    ds_read_b32 v39, v39
    s_add_u32 m0, s35, 63488
    s_nop 0
    buffer_load_dwordx4 v1, s[8:11], s25 offen  lds
    s_add_u32 s25, s25, 36864
    s_waitcnt lgkmcnt(8)
    v_perm_b32 v8, v28, v24, s36
    v_perm_b32 v12, v29, v25, s37
    v_perm_b32 v16, v30, v26, s36
    s_add_u32 m0, s35, 67584
    s_nop 0
    buffer_load_dwordx4 v1, s[8:11], s25 offen  lds
    s_add_u32 s25, s25, 36864
    v_perm_b32 v20, v31, v27, s37
    s_waitcnt vmcnt(18)
    v_lshl_add_u32 v40, v40, 7, v3
    ds_read_b32 v40, v40
    v_lshl_add_u32 v41, v41, 7, v3
    ds_read_b32 v41, v41
    s_add_u32 m0, s35, 71680
    s_nop 0
    buffer_load_dwordx4 v1, s[8:11], s25 offen  lds
    s_add_u32 s25, s25, 36864
    v_lshl_add_u32 v42, v42, 7, v4
    ds_read_b32 v42, v42
    v_lshl_add_u32 v43, v43, 7, v4
    ds_read_b32 v43, v43
    s_add_u32 m0, s35, 75776
    s_mov_b64 exec, s[38:39]
    buffer_load_dwordx4 v1, s[8:11], s25 offen  lds
    s_mov_b64 exec, -1
    s_sub_u32 s25, s25, 331648
    v_lshl_add_u32 v44, v44, 7, v3
    ds_read_b32 v44, v44
    v_lshl_add_u32 v45, v45, 7, v3
    ds_read_b32 v45, v45
    v_lshl_add_u32 v46, v46, 7, v4
    ds_read_b32 v46, v46
    buffer_load_dwordx4 v[88:91], v2, s[12:15], s24 offen
    s_add_u32 s24, s24, 18432
    v_lshl_add_u32 v47, v47, 7, v4
    ds_read_b32 v47, v47
    s_waitcnt lgkmcnt(8)
    v_perm_b32 v9, v36, v32, s36
    v_perm_b32 v13, v37, v33, s37
    buffer_load_dwordx4 v[92:95], v2, s[12:15], s24 offen
    s_add_u32 s24, s24, 18432
    v_perm_b32 v17, v38, v34, s36
    v_perm_b32 v21, v39, v35, s37
    buffer_load_dwordx4 v[96:99], v2, s[12:15], s24 offen
    s_add_u32 s24, s24, 18432
    s_waitcnt vmcnt(20)
    v_lshl_add_u32 v48, v48, 7, v3
    ds_read_b32 v48, v48
    v_lshl_add_u32 v49, v49, 7, v3
    ds_read_b32 v49, v49
    v_lshl_add_u32 v50, v50, 7, v4
    ds_read_b32 v50, v50
    buffer_load_dwordx4 v[100:103], v2, s[12:15], s24 offen
    s_add_u32 s24, s24, 18432
    v_lshl_add_u32 v51, v51, 7, v4
    ds_read_b32 v51, v51
    v_lshl_add_u32 v52, v52, 7, v3
    ds_read_b32 v52, v52
    v_lshl_add_u32 v53, v53, 7, v3
    ds_read_b32 v53, v53
    buffer_load_dwordx4 v[104:107], v2, s[12:15], s24 offen
    s_add_u32 s24, s24, 18432
    v_lshl_add_u32 v54, v54, 7, v4
    ds_read_b32 v54, v54
    v_lshl_add_u32 v55, v55, 7, v4
    ds_read_b32 v55, v55
    buffer_load_dwordx4 v[108:111], v2, s[12:15], s24 offen
    s_add_u32 s24, s24, 18432
    s_waitcnt lgkmcnt(8)
    v_perm_b32 v10, v44, v40, s36
    v_perm_b32 v14, v45, v41, s37
    v_perm_b32 v18, v46, v42, s36
    buffer_load_dwordx4 v[112:115], v2, s[12:15], s24 offen
    s_add_u32 s24, s24, 18432
    v_perm_b32 v22, v47, v43, s37
    s_waitcnt lgkmcnt(0)
    v_perm_b32 v11, v52, v48, s36
    ds_write_b128 v5, v[8:11] offset:0
    v_perm_b32 v15, v53, v49, s37
    ds_write_b128 v5, v[12:15] offset:1024
    buffer_load_dwordx4 v[116:119], v2, s[12:15], s24 offen
    s_add_u32 s24, s24, 1050624
    v_perm_b32 v19, v54, v50, s36
    ds_write_b128 v6, v[16:19] offset:0
    v_perm_b32 v23, v55, v51, s37
    ds_write_b128 v6, v[20:23] offset:1024
    s_waitcnt lgkmcnt(0)
    s_barrier
    s_add_u32 m0, s35, 77824
    s_nop 0
    buffer_load_dwordx4 v1, s[8:11], s25 offen  lds
    s_add_u32 s25, s25, 36864
    s_waitcnt vmcnt(24)
    v_lshl_add_u32 v56, v56, 7, v3
    ds_read_b32 v56, v56
    v_lshl_add_u32 v57, v57, 7, v3
    ds_read_b32 v57, v57
    v_lshl_add_u32 v58, v58, 7, v4
    ds_read_b32 v58, v58
    s_add_u32 m0, s35, 81920
    s_nop 0
    buffer_load_dwordx4 v1, s[8:11], s25 offen  lds
    s_add_u32 s25, s25, 36864
    v_lshl_add_u32 v59, v59, 7, v4
    ds_read_b32 v59, v59
    v_lshl_add_u32 v60, v60, 7, v3
    ds_read_b32 v60, v60
    v_lshl_add_u32 v61, v61, 7, v3
    ds_read_b32 v61, v61
    s_add_u32 m0, s35, 86016
    s_nop 0
    buffer_load_dwordx4 v1, s[8:11], s25 offen  lds
    s_add_u32 s25, s25, 36864
    v_lshl_add_u32 v62, v62, 7, v4
    ds_read_b32 v62, v62
    v_lshl_add_u32 v63, v63, 7, v4
    ds_read_b32 v63, v63
    s_add_u32 m0, s35, 90112
    s_nop 0
    buffer_load_dwordx4 v1, s[8:11], s25 offen  lds
    s_add_u32 s25, s25, 36864
    s_waitcnt vmcnt(25)
    v_lshl_add_u32 v64, v64, 7, v3
    ds_read_b32 v64, v64
    v_lshl_add_u32 v65, v65, 7, v3
    ds_read_b32 v65, v65
    v_lshl_add_u32 v66, v66, 7, v4
    ds_read_b32 v66, v66
    s_add_u32 m0, s35, 94208
    s_nop 0
    buffer_load_dwordx4 v1, s[8:11], s25 offen  lds
    s_add_u32 s25, s25, 36864
    v_lshl_add_u32 v67, v67, 7, v4
    ds_read_b32 v67, v67
    v_lshl_add_u32 v68, v68, 7, v3
    ds_read_b32 v68, v68
    v_lshl_add_u32 v69, v69, 7, v3
    ds_read_b32 v69, v69
    s_add_u32 m0, s35, 98304
    s_nop 0
    buffer_load_dwordx4 v1, s[8:11], s25 offen  lds
    s_add_u32 s25, s25, 36864
    v_lshl_add_u32 v70, v70, 7, v4
    ds_read_b32 v70, v70
    v_lshl_add_u32 v71, v71, 7, v4
    ds_read_b32 v71, v71
    s_add_u32 m0, s35, 102400
    s_nop 0
    buffer_load_dwordx4 v1, s[8:11], s25 offen  lds
    s_add_u32 s25, s25, 36864
    s_waitcnt lgkmcnt(8)
    v_perm_b32 v8, v60, v56, s36
    v_perm_b32 v12, v61, v57, s37
    v_perm_b32 v16, v62, v58, s36
    s_add_u32 m0, s35, 106496
    s_nop 0
    buffer_load_dwordx4 v1, s[8:11], s25 offen  lds
    s_add_u32 s25, s25, 36864
    v_perm_b32 v20, v63, v59, s37
    s_waitcnt vmcnt(27)
    v_lshl_add_u32 v72, v72, 7, v3
    ds_read_b32 v72, v72
    v_lshl_add_u32 v73, v73, 7, v3
    ds_read_b32 v73, v73
    s_add_u32 m0, s35, 110592
    s_nop 0
    buffer_load_dwordx4 v1, s[8:11], s25 offen  lds
    s_add_u32 s25, s25, 36864
    v_lshl_add_u32 v74, v74, 7, v4
    ds_read_b32 v74, v74
    v_lshl_add_u32 v75, v75, 7, v4
    ds_read_b32 v75, v75
    s_add_u32 m0, s35, 114688
    s_mov_b64 exec, s[38:39]
    buffer_load_dwordx4 v1, s[8:11], s25 offen  lds
    s_mov_b64 exec, -1
    s_sub_u32 s25, s25, 331648
    v_lshl_add_u32 v76, v76, 7, v3
    ds_read_b32 v76, v76
    v_lshl_add_u32 v77, v77, 7, v3
    ds_read_b32 v77, v77
    v_lshl_add_u32 v78, v78, 7, v4
    ds_read_b32 v78, v78
    buffer_load_dwordx4 v[120:123], v2, s[12:15], s24 offen
    s_add_u32 s24, s24, 18432
    v_lshl_add_u32 v79, v79, 7, v4
    ds_read_b32 v79, v79
    s_waitcnt lgkmcnt(8)
    v_perm_b32 v9, v68, v64, s36
    v_perm_b32 v13, v69, v65, s37
    buffer_load_dwordx4 v[124:127], v2, s[12:15], s24 offen
    s_add_u32 s24, s24, 18432
    v_perm_b32 v17, v70, v66, s36
    v_perm_b32 v21, v71, v67, s37
    buffer_load_dwordx4 v[128:131], v2, s[12:15], s24 offen
    s_add_u32 s24, s24, 18432
    s_waitcnt vmcnt(29)
    v_lshl_add_u32 v80, v80, 7, v3
    ds_read_b32 v80, v80
    v_lshl_add_u32 v81, v81, 7, v3
    ds_read_b32 v81, v81
    v_lshl_add_u32 v82, v82, 7, v4
    ds_read_b32 v82, v82
    buffer_load_dwordx4 v[132:135], v2, s[12:15], s24 offen
    s_add_u32 s24, s24, 18432
    v_lshl_add_u32 v83, v83, 7, v4
    ds_read_b32 v83, v83
    v_lshl_add_u32 v84, v84, 7, v3
    ds_read_b32 v84, v84
    v_lshl_add_u32 v85, v85, 7, v3
    ds_read_b32 v85, v85
    buffer_load_dwordx4 v[136:139], v2, s[12:15], s24 offen
    s_add_u32 s24, s24, 18432
    v_lshl_add_u32 v86, v86, 7, v4
    ds_read_b32 v86, v86
    v_lshl_add_u32 v87, v87, 7, v4
    ds_read_b32 v87, v87
    buffer_load_dwordx4 v[140:143], v2, s[12:15], s24 offen
    s_add_u32 s24, s24, 18432
    s_waitcnt lgkmcnt(8)
    v_perm_b32 v10, v76, v72, s36
    v_perm_b32 v14, v77, v73, s37
    v_perm_b32 v18, v78, v74, s36
    buffer_load_dwordx4 v[144:147], v2, s[12:15], s24 offen
    s_add_u32 s24, s24, 18432
    v_perm_b32 v22, v79, v75, s37
    s_waitcnt lgkmcnt(0)
    v_perm_b32 v11, v84, v80, s36
    ds_write_b128 v5, v[8:11] offset:16384
    v_perm_b32 v15, v85, v81, s37
    ds_write_b128 v5, v[12:15] offset:17408
    buffer_load_dwordx4 v[148:151], v2, s[12:15], s24 offen
    s_add_u32 s24, s24, 1050624
    v_perm_b32 v19, v86, v82, s36
    ds_write_b128 v6, v[16:19] offset:16384
    v_perm_b32 v23, v87, v83, s37
    ds_write_b128 v6, v[20:23] offset:17408
    s_waitcnt vmcnt(25)
    s_waitcnt lgkmcnt(0)
    s_barrier
    s_add_u32 m0, s35, 0
    s_nop 0
    buffer_load_dwordx4 v1, s[8:11], s25 offen  lds
    s_add_u32 s25, s25, 36864
    s_waitcnt vmcnt(24)
    v_lshl_add_u32 v88, v88, 7, v3
    ds_read_b32 v88, v88
    v_lshl_add_u32 v89, v89, 7, v3
    ds_read_b32 v89, v89
    v_lshl_add_u32 v90, v90, 7, v4
    ds_read_b32 v90, v90
    s_add_u32 m0, s35, 4096
    s_nop 0
    buffer_load_dwordx4 v1, s[8:11], s25 offen  lds
    s_add_u32 s25, s25, 36864
    v_lshl_add_u32 v91, v91, 7, v4
    ds_read_b32 v91, v91
    v_lshl_add_u32 v92, v92, 7, v3
    ds_read_b32 v92, v92
    v_lshl_add_u32 v93, v93, 7, v3
    ds_read_b32 v93, v93
    s_add_u32 m0, s35, 8192
    s_nop 0
    buffer_load_dwordx4 v1, s[8:11], s25 offen  lds
    s_add_u32 s25, s25, 36864
    v_lshl_add_u32 v94, v94, 7, v4
    ds_read_b32 v94, v94
    v_lshl_add_u32 v95, v95, 7, v4
    ds_read_b32 v95, v95
    s_add_u32 m0, s35, 12288
    s_nop 0
    buffer_load_dwordx4 v1, s[8:11], s25 offen  lds
    s_add_u32 s25, s25, 36864
    s_waitcnt vmcnt(25)
    v_lshl_add_u32 v96, v96, 7, v3
    ds_read_b32 v96, v96
    v_lshl_add_u32 v97, v97, 7, v3
    ds_read_b32 v97, v97
    v_lshl_add_u32 v98, v98, 7, v4
    ds_read_b32 v98, v98
    s_add_u32 m0, s35, 16384
    s_nop 0
    buffer_load_dwordx4 v1, s[8:11], s25 offen  lds
    s_add_u32 s25, s25, 36864
    v_lshl_add_u32 v99, v99, 7, v4
    ds_read_b32 v99, v99
    v_lshl_add_u32 v100, v100, 7, v3
    ds_read_b32 v100, v100
    v_lshl_add_u32 v101, v101, 7, v3
    ds_read_b32 v101, v101
    s_add_u32 m0, s35, 20480
    s_nop 0
    buffer_load_dwordx4 v1, s[8:11], s25 offen  lds
    s_add_u32 s25, s25, 36864
    v_lshl_add_u32 v102, v102, 7, v4
    ds_read_b32 v102, v102
    v_lshl_add_u32 v103, v103, 7, v4
    ds_read_b32 v103, v103
    s_add_u32 m0, s35, 24576
    s_nop 0
    buffer_load_dwordx4 v1, s[8:11], s25 offen  lds
    s_add_u32 s25, s25, 36864
    s_waitcnt lgkmcnt(8)
    v_perm_b32 v8, v92, v88, s36
    v_perm_b32 v12, v93, v89, s37
    v_perm_b32 v16, v94, v90, s36
    s_add_u32 m0, s35, 28672
    s_nop 0
    buffer_load_dwordx4 v1, s[8:11], s25 offen  lds
    s_add_u32 s25, s25, 36864
    v_perm_b32 v20, v95, v91, s37
    s_waitcnt vmcnt(27)
    v_lshl_add_u32 v104, v104, 7, v3
    ds_read_b32 v104, v104
    v_lshl_add_u32 v105, v105, 7, v3
    ds_read_b32 v105, v105
    s_add_u32 m0, s35, 32768
    s_nop 0
    buffer_load_dwordx4 v1, s[8:11], s25 offen  lds
    s_add_u32 s25, s25, 36864
    v_lshl_add_u32 v106, v106, 7, v4
    ds_read_b32 v106, v106
    v_lshl_add_u32 v107, v107, 7, v4
    ds_read_b32 v107, v107
    s_add_u32 m0, s35, 36864
    s_mov_b64 exec, s[38:39]
    buffer_load_dwordx4 v1, s[8:11], s25 offen  lds
    s_mov_b64 exec, -1
    s_sub_u32 s25, s25, 331648
    v_lshl_add_u32 v108, v108, 7, v3
    ds_read_b32 v108, v108
    v_lshl_add_u32 v109, v109, 7, v3
    ds_read_b32 v109, v109
    v_lshl_add_u32 v110, v110, 7, v4
    ds_read_b32 v110, v110
    buffer_load_dwordx4 v[24:27], v2, s[12:15], s24 offen
    s_add_u32 s24, s24, 18432
    v_lshl_add_u32 v111, v111, 7, v4
    ds_read_b32 v111, v111
    s_waitcnt lgkmcnt(8)
    v_perm_b32 v9, v100, v96, s36
    v_perm_b32 v13, v101, v97, s37
    buffer_load_dwordx4 v[28:31], v2, s[12:15], s24 offen
    s_add_u32 s24, s24, 18432
    v_perm_b32 v17, v102, v98, s36
    v_perm_b32 v21, v103, v99, s37
    buffer_load_dwordx4 v[32:35], v2, s[12:15], s24 offen
    s_add_u32 s24, s24, 18432
    s_waitcnt vmcnt(29)
    v_lshl_add_u32 v112, v112, 7, v3
    ds_read_b32 v112, v112
    v_lshl_add_u32 v113, v113, 7, v3
    ds_read_b32 v113, v113
    v_lshl_add_u32 v114, v114, 7, v4
    ds_read_b32 v114, v114
    buffer_load_dwordx4 v[36:39], v2, s[12:15], s24 offen
    s_add_u32 s24, s24, 18432
    v_lshl_add_u32 v115, v115, 7, v4
    ds_read_b32 v115, v115
    v_lshl_add_u32 v116, v116, 7, v3
    ds_read_b32 v116, v116
    v_lshl_add_u32 v117, v117, 7, v3
    ds_read_b32 v117, v117
    buffer_load_dwordx4 v[40:43], v2, s[12:15], s24 offen
    s_add_u32 s24, s24, 18432
    v_lshl_add_u32 v118, v118, 7, v4
    ds_read_b32 v118, v118
    v_lshl_add_u32 v119, v119, 7, v4
    ds_read_b32 v119, v119
    buffer_load_dwordx4 v[44:47], v2, s[12:15], s24 offen
    s_add_u32 s24, s24, 18432
    s_waitcnt lgkmcnt(8)
    v_perm_b32 v10, v108, v104, s36
    v_perm_b32 v14, v109, v105, s37
    v_perm_b32 v18, v110, v106, s36
    buffer_load_dwordx4 v[48:51], v2, s[12:15], s24 offen
    s_add_u32 s24, s24, 18432
    v_perm_b32 v22, v111, v107, s37
    s_waitcnt lgkmcnt(0)
    v_perm_b32 v11, v116, v112, s36
    ds_write_b128 v5, v[8:11] offset:0
    v_perm_b32 v15, v117, v113, s37
    ds_write_b128 v5, v[12:15] offset:1024
    buffer_load_dwordx4 v[52:55], v2, s[12:15], s24 offen
    s_add_u32 s24, s24, 1050624
    v_perm_b32 v19, v118, v114, s36
    ds_write_b128 v6, v[16:19] offset:0
    v_perm_b32 v23, v119, v115, s37
    ds_write_b128 v6, v[20:23] offset:1024
    s_waitcnt vmcnt(25)
    s_waitcnt lgkmcnt(0)
    s_barrier
    s_add_u32 m0, s35, 38912
    s_nop 0
    buffer_load_dwordx4 v1, s[8:11], s25 offen  lds
    s_add_u32 s25, s25, 36864
    s_waitcnt vmcnt(24)
    v_lshl_add_u32 v120, v120, 7, v3
    ds_read_b32 v120, v120
    v_lshl_add_u32 v121, v121, 7, v3
    ds_read_b32 v121, v121
    v_lshl_add_u32 v122, v122, 7, v4
    ds_read_b32 v122, v122
    s_add_u32 m0, s35, 43008
    s_nop 0
    buffer_load_dwordx4 v1, s[8:11], s25 offen  lds
    s_add_u32 s25, s25, 36864
    v_lshl_add_u32 v123, v123, 7, v4
    ds_read_b32 v123, v123
    v_lshl_add_u32 v124, v124, 7, v3
    ds_read_b32 v124, v124
    v_lshl_add_u32 v125, v125, 7, v3
    ds_read_b32 v125, v125
    s_add_u32 m0, s35, 47104
    s_nop 0
    buffer_load_dwordx4 v1, s[8:11], s25 offen  lds
    s_add_u32 s25, s25, 36864
    v_lshl_add_u32 v126, v126, 7, v4
    ds_read_b32 v126, v126
    v_lshl_add_u32 v127, v127, 7, v4
    ds_read_b32 v127, v127
    s_add_u32 m0, s35, 51200
    s_nop 0
    buffer_load_dwordx4 v1, s[8:11], s25 offen  lds
    s_add_u32 s25, s25, 36864
    s_waitcnt vmcnt(25)
    v_lshl_add_u32 v128, v128, 7, v3
    ds_read_b32 v128, v128
    v_lshl_add_u32 v129, v129, 7, v3
    ds_read_b32 v129, v129
    v_lshl_add_u32 v130, v130, 7, v4
    ds_read_b32 v130, v130
    s_add_u32 m0, s35, 55296
    s_nop 0
    buffer_load_dwordx4 v1, s[8:11], s25 offen  lds
    s_add_u32 s25, s25, 36864
    v_lshl_add_u32 v131, v131, 7, v4
    ds_read_b32 v131, v131
    v_lshl_add_u32 v132, v132, 7, v3
    ds_read_b32 v132, v132
    v_lshl_add_u32 v133, v133, 7, v3
    ds_read_b32 v133, v133
    s_add_u32 m0, s35, 59392
    s_nop 0
    buffer_load_dwordx4 v1, s[8:11], s25 offen  lds
    s_add_u32 s25, s25, 36864
    v_lshl_add_u32 v134, v134, 7, v4
    ds_read_b32 v134, v134
    v_lshl_add_u32 v135, v135, 7, v4
    ds_read_b32 v135, v135
    s_add_u32 m0, s35, 63488
    s_nop 0
    buffer_load_dwordx4 v1, s[8:11], s25 offen  lds
    s_add_u32 s25, s25, 36864
    s_waitcnt lgkmcnt(8)
    v_perm_b32 v8, v124, v120, s36
    v_perm_b32 v12, v125, v121, s37
    v_perm_b32 v16, v126, v122, s36
    s_add_u32 m0, s35, 67584
    s_nop 0
    buffer_load_dwordx4 v1, s[8:11], s25 offen  lds
    s_add_u32 s25, s25, 36864
    v_perm_b32 v20, v127, v123, s37
    s_waitcnt vmcnt(27)
    v_lshl_add_u32 v136, v136, 7, v3
    ds_read_b32 v136, v136
    v_lshl_add_u32 v137, v137, 7, v3
    ds_read_b32 v137, v137
    s_add_u32 m0, s35, 71680
    s_nop 0
    buffer_load_dwordx4 v1, s[8:11], s25 offen  lds
    s_add_u32 s25, s25, 36864
    v_lshl_add_u32 v138, v138, 7, v4
    ds_read_b32 v138, v138
    v_lshl_add_u32 v139, v139, 7, v4
    ds_read_b32 v139, v139
    s_add_u32 m0, s35, 75776
    s_mov_b64 exec, s[38:39]
    buffer_load_dwordx4 v1, s[8:11], s25 offen  lds
    s_mov_b64 exec, -1
    s_sub_u32 s25, s25, 331648
    v_lshl_add_u32 v140, v140, 7, v3
    ds_read_b32 v140, v140
    v_lshl_add_u32 v141, v141, 7, v3
    ds_read_b32 v141, v141
    v_lshl_add_u32 v142, v142, 7, v4
    ds_read_b32 v142, v142
    buffer_load_dwordx4 v[56:59], v2, s[12:15], s24 offen
    s_add_u32 s24, s24, 18432
    v_lshl_add_u32 v143, v143, 7, v4
    ds_read_b32 v143, v143
    s_waitcnt lgkmcnt(8)
    v_perm_b32 v9, v132, v128, s36
    v_perm_b32 v13, v133, v129, s37
    buffer_load_dwordx4 v[60:63], v2, s[12:15], s24 offen
    s_add_u32 s24, s24, 18432
    v_perm_b32 v17, v134, v130, s36
    v_perm_b32 v21, v135, v131, s37
    buffer_load_dwordx4 v[64:67], v2, s[12:15], s24 offen
    s_add_u32 s24, s24, 18432
    s_waitcnt vmcnt(29)
    v_lshl_add_u32 v144, v144, 7, v3
    ds_read_b32 v144, v144
    v_lshl_add_u32 v145, v145, 7, v3
    ds_read_b32 v145, v145
    v_lshl_add_u32 v146, v146, 7, v4
    ds_read_b32 v146, v146
    buffer_load_dwordx4 v[68:71], v2, s[12:15], s24 offen
    s_add_u32 s24, s24, 18432
    v_lshl_add_u32 v147, v147, 7, v4
    ds_read_b32 v147, v147
    v_lshl_add_u32 v148, v148, 7, v3
    ds_read_b32 v148, v148
    v_lshl_add_u32 v149, v149, 7, v3
    ds_read_b32 v149, v149
    buffer_load_dwordx4 v[72:75], v2, s[12:15], s24 offen
    s_add_u32 s24, s24, 18432
    v_lshl_add_u32 v150, v150, 7, v4
    ds_read_b32 v150, v150
    v_lshl_add_u32 v151, v151, 7, v4
    ds_read_b32 v151, v151
    buffer_load_dwordx4 v[76:79], v2, s[12:15], s24 offen
    s_add_u32 s24, s24, 18432
    s_waitcnt lgkmcnt(8)
    v_perm_b32 v10, v140, v136, s36
    v_perm_b32 v14, v141, v137, s37
    v_perm_b32 v18, v142, v138, s36
    buffer_load_dwordx4 v[80:83], v2, s[12:15], s24 offen
    s_add_u32 s24, s24, 18432
    v_perm_b32 v22, v143, v139, s37
    s_waitcnt lgkmcnt(0)
    v_perm_b32 v11, v148, v144, s36
    ds_write_b128 v5, v[8:11] offset:16384
    v_perm_b32 v15, v149, v145, s37
    ds_write_b128 v5, v[12:15] offset:17408
    buffer_load_dwordx4 v[84:87], v2, s[12:15], s24 offen
    s_add_u32 s24, s24, 1050624
    v_perm_b32 v19, v150, v146, s36
    ds_write_b128 v6, v[16:19] offset:16384
    v_perm_b32 v23, v151, v147, s37
    ds_write_b128 v6, v[20:23] offset:17408
    s_waitcnt vmcnt(25)
    s_waitcnt lgkmcnt(0)
    s_barrier
    s_add_u32 m0, s35, 77824
    s_nop 0
    buffer_load_dwordx4 v1, s[8:11], s25 offen  lds
    s_add_u32 s25, s25, 36864
    s_waitcnt vmcnt(24)
    v_lshl_add_u32 v24, v24, 7, v3
    ds_read_b32 v24, v24
    v_lshl_add_u32 v25, v25, 7, v3
    ds_read_b32 v25, v25
    v_lshl_add_u32 v26, v26, 7, v4
    ds_read_b32 v26, v26
    s_add_u32 m0, s35, 81920
    s_nop 0
    buffer_load_dwordx4 v1, s[8:11], s25 offen  lds
    s_add_u32 s25, s25, 36864
    v_lshl_add_u32 v27, v27, 7, v4
    ds_read_b32 v27, v27
    v_lshl_add_u32 v28, v28, 7, v3
    ds_read_b32 v28, v28
    v_lshl_add_u32 v29, v29, 7, v3
    ds_read_b32 v29, v29
    s_add_u32 m0, s35, 86016
    s_nop 0
    buffer_load_dwordx4 v1, s[8:11], s25 offen  lds
    s_add_u32 s25, s25, 36864
    v_lshl_add_u32 v30, v30, 7, v4
    ds_read_b32 v30, v30
    v_lshl_add_u32 v31, v31, 7, v4
    ds_read_b32 v31, v31
    s_add_u32 m0, s35, 90112
    s_nop 0
    buffer_load_dwordx4 v1, s[8:11], s25 offen  lds
    s_add_u32 s25, s25, 36864
    s_waitcnt vmcnt(25)
    v_lshl_add_u32 v32, v32, 7, v3
    ds_read_b32 v32, v32
    v_lshl_add_u32 v33, v33, 7, v3
    ds_read_b32 v33, v33
    v_lshl_add_u32 v34, v34, 7, v4
    ds_read_b32 v34, v34
    s_add_u32 m0, s35, 94208
    s_nop 0
    buffer_load_dwordx4 v1, s[8:11], s25 offen  lds
    s_add_u32 s25, s25, 36864
    v_lshl_add_u32 v35, v35, 7, v4
    ds_read_b32 v35, v35
    v_lshl_add_u32 v36, v36, 7, v3
    ds_read_b32 v36, v36
    v_lshl_add_u32 v37, v37, 7, v3
    ds_read_b32 v37, v37
    s_add_u32 m0, s35, 98304
    s_nop 0
    buffer_load_dwordx4 v1, s[8:11], s25 offen  lds
    s_add_u32 s25, s25, 36864
    v_lshl_add_u32 v38, v38, 7, v4
    ds_read_b32 v38, v38
    v_lshl_add_u32 v39, v39, 7, v4
    ds_read_b32 v39, v39
    s_add_u32 m0, s35, 102400
    s_nop 0
    buffer_load_dwordx4 v1, s[8:11], s25 offen  lds
    s_add_u32 s25, s25, 36864
    s_waitcnt lgkmcnt(8)
    v_perm_b32 v8, v28, v24, s36
    v_perm_b32 v12, v29, v25, s37
    v_perm_b32 v16, v30, v26, s36
    s_add_u32 m0, s35, 106496
    s_nop 0
    buffer_load_dwordx4 v1, s[8:11], s25 offen  lds
    s_add_u32 s25, s25, 36864
    v_perm_b32 v20, v31, v27, s37
    s_waitcnt vmcnt(27)
    v_lshl_add_u32 v40, v40, 7, v3
    ds_read_b32 v40, v40
    v_lshl_add_u32 v41, v41, 7, v3
    ds_read_b32 v41, v41
    s_add_u32 m0, s35, 110592
    s_nop 0
    buffer_load_dwordx4 v1, s[8:11], s25 offen  lds
    s_add_u32 s25, s25, 36864
    v_lshl_add_u32 v42, v42, 7, v4
    ds_read_b32 v42, v42
    v_lshl_add_u32 v43, v43, 7, v4
    ds_read_b32 v43, v43
    s_add_u32 m0, s35, 114688
    s_mov_b64 exec, s[38:39]
    buffer_load_dwordx4 v1, s[8:11], s25 offen  lds
    s_mov_b64 exec, -1
    s_sub_u32 s25, s25, 331648
    v_lshl_add_u32 v44, v44, 7, v3
    ds_read_b32 v44, v44
    v_lshl_add_u32 v45, v45, 7, v3
    ds_read_b32 v45, v45
    v_lshl_add_u32 v46, v46, 7, v4
    ds_read_b32 v46, v46
    buffer_load_dwordx4 v[88:91], v2, s[12:15], s24 offen
    s_add_u32 s24, s24, 18432
    v_lshl_add_u32 v47, v47, 7, v4
    ds_read_b32 v47, v47
    s_waitcnt lgkmcnt(8)
    v_perm_b32 v9, v36, v32, s36
    v_perm_b32 v13, v37, v33, s37
    buffer_load_dwordx4 v[92:95], v2, s[12:15], s24 offen
    s_add_u32 s24, s24, 18432
    v_perm_b32 v17, v38, v34, s36
    v_perm_b32 v21, v39, v35, s37
    buffer_load_dwordx4 v[96:99], v2, s[12:15], s24 offen
    s_add_u32 s24, s24, 18432
    s_waitcnt vmcnt(29)
    v_lshl_add_u32 v48, v48, 7, v3
    ds_read_b32 v48, v48
    v_lshl_add_u32 v49, v49, 7, v3
    ds_read_b32 v49, v49
    v_lshl_add_u32 v50, v50, 7, v4
    ds_read_b32 v50, v50
    buffer_load_dwordx4 v[100:103], v2, s[12:15], s24 offen
    s_add_u32 s24, s24, 18432
    v_lshl_add_u32 v51, v51, 7, v4
    ds_read_b32 v51, v51
    v_lshl_add_u32 v52, v52, 7, v3
    ds_read_b32 v52, v52
    v_lshl_add_u32 v53, v53, 7, v3
    ds_read_b32 v53, v53
    buffer_load_dwordx4 v[104:107], v2, s[12:15], s24 offen
    s_add_u32 s24, s24, 18432
    v_lshl_add_u32 v54, v54, 7, v4
    ds_read_b32 v54, v54
    v_lshl_add_u32 v55, v55, 7, v4
    ds_read_b32 v55, v55
    buffer_load_dwordx4 v[108:111], v2, s[12:15], s24 offen
    s_add_u32 s24, s24, 18432
    s_waitcnt lgkmcnt(8)
    v_perm_b32 v10, v44, v40, s36
    v_perm_b32 v14, v45, v41, s37
    v_perm_b32 v18, v46, v42, s36
    buffer_load_dwordx4 v[112:115], v2, s[12:15], s24 offen
    s_add_u32 s24, s24, 18432
    v_perm_b32 v22, v47, v43, s37
    s_waitcnt lgkmcnt(0)
    v_perm_b32 v11, v52, v48, s36
    ds_write_b128 v5, v[8:11] offset:0
    v_perm_b32 v15, v53, v49, s37
    ds_write_b128 v5, v[12:15] offset:1024
    buffer_load_dwordx4 v[116:119], v2, s[12:15], s24 offen
    s_add_u32 s24, s24, 1050624
    v_perm_b32 v19, v54, v50, s36
    ds_write_b128 v6, v[16:19] offset:0
    v_perm_b32 v23, v55, v51, s37
    ds_write_b128 v6, v[20:23] offset:1024
    s_waitcnt vmcnt(25)
    s_waitcnt lgkmcnt(0)
    s_barrier
    s_add_u32 m0, s35, 0
    s_nop 0
    buffer_load_dwordx4 v1, s[8:11], s25 offen  lds
    s_add_u32 s25, s25, 36864
    s_waitcnt vmcnt(24)
    v_lshl_add_u32 v56, v56, 7, v3
    ds_read_b32 v56, v56
    v_lshl_add_u32 v57, v57, 7, v3
    ds_read_b32 v57, v57
    v_lshl_add_u32 v58, v58, 7, v4
    ds_read_b32 v58, v58
    s_add_u32 m0, s35, 4096
    s_nop 0
    buffer_load_dwordx4 v1, s[8:11], s25 offen  lds
    s_add_u32 s25, s25, 36864
    v_lshl_add_u32 v59, v59, 7, v4
    ds_read_b32 v59, v59
    v_lshl_add_u32 v60, v60, 7, v3
    ds_read_b32 v60, v60
    v_lshl_add_u32 v61, v61, 7, v3
    ds_read_b32 v61, v61
    s_add_u32 m0, s35, 8192
    s_nop 0
    buffer_load_dwordx4 v1, s[8:11], s25 offen  lds
    s_add_u32 s25, s25, 36864
    v_lshl_add_u32 v62, v62, 7, v4
    ds_read_b32 v62, v62
    v_lshl_add_u32 v63, v63, 7, v4
    ds_read_b32 v63, v63
    s_add_u32 m0, s35, 12288
    s_nop 0
    buffer_load_dwordx4 v1, s[8:11], s25 offen  lds
    s_add_u32 s25, s25, 36864
    s_waitcnt vmcnt(25)
    v_lshl_add_u32 v64, v64, 7, v3
    ds_read_b32 v64, v64
    v_lshl_add_u32 v65, v65, 7, v3
    ds_read_b32 v65, v65
    v_lshl_add_u32 v66, v66, 7, v4
    ds_read_b32 v66, v66
    s_add_u32 m0, s35, 16384
    s_nop 0
    buffer_load_dwordx4 v1, s[8:11], s25 offen  lds
    s_add_u32 s25, s25, 36864
    v_lshl_add_u32 v67, v67, 7, v4
    ds_read_b32 v67, v67
    v_lshl_add_u32 v68, v68, 7, v3
    ds_read_b32 v68, v68
    v_lshl_add_u32 v69, v69, 7, v3
    ds_read_b32 v69, v69
    s_add_u32 m0, s35, 20480
    s_nop 0
    buffer_load_dwordx4 v1, s[8:11], s25 offen  lds
    s_add_u32 s25, s25, 36864
    v_lshl_add_u32 v70, v70, 7, v4
    ds_read_b32 v70, v70
    v_lshl_add_u32 v71, v71, 7, v4
    ds_read_b32 v71, v71
    s_add_u32 m0, s35, 24576
    s_nop 0
    buffer_load_dwordx4 v1, s[8:11], s25 offen  lds
    s_add_u32 s25, s25, 36864
    s_waitcnt lgkmcnt(8)
    v_perm_b32 v8, v60, v56, s36
    v_perm_b32 v12, v61, v57, s37
    v_perm_b32 v16, v62, v58, s36
    s_add_u32 m0, s35, 28672
    s_nop 0
    buffer_load_dwordx4 v1, s[8:11], s25 offen  lds
    s_add_u32 s25, s25, 36864
    v_perm_b32 v20, v63, v59, s37
    s_waitcnt vmcnt(27)
    v_lshl_add_u32 v72, v72, 7, v3
    ds_read_b32 v72, v72
    v_lshl_add_u32 v73, v73, 7, v3
    ds_read_b32 v73, v73
    s_add_u32 m0, s35, 32768
    s_nop 0
    buffer_load_dwordx4 v1, s[8:11], s25 offen  lds
    s_add_u32 s25, s25, 36864
    v_lshl_add_u32 v74, v74, 7, v4
    ds_read_b32 v74, v74
    v_lshl_add_u32 v75, v75, 7, v4
    ds_read_b32 v75, v75
    s_add_u32 m0, s35, 36864
    s_mov_b64 exec, s[38:39]
    buffer_load_dwordx4 v1, s[8:11], s25 offen  lds
    s_mov_b64 exec, -1
    s_sub_u32 s25, s25, 331648
    v_lshl_add_u32 v76, v76, 7, v3
    ds_read_b32 v76, v76
    v_lshl_add_u32 v77, v77, 7, v3
    ds_read_b32 v77, v77
    v_lshl_add_u32 v78, v78, 7, v4
    ds_read_b32 v78, v78
    buffer_load_dwordx4 v[120:123], v2, s[12:15], s24 offen
    s_add_u32 s24, s24, 18432
    v_lshl_add_u32 v79, v79, 7, v4
    ds_read_b32 v79, v79
    s_waitcnt lgkmcnt(8)
    v_perm_b32 v9, v68, v64, s36
    v_perm_b32 v13, v69, v65, s37
    buffer_load_dwordx4 v[124:127], v2, s[12:15], s24 offen
    s_add_u32 s24, s24, 18432
    v_perm_b32 v17, v70, v66, s36
    v_perm_b32 v21, v71, v67, s37
    buffer_load_dwordx4 v[128:131], v2, s[12:15], s24 offen
    s_add_u32 s24, s24, 18432
    s_waitcnt vmcnt(29)
    v_lshl_add_u32 v80, v80, 7, v3
    ds_read_b32 v80, v80
    v_lshl_add_u32 v81, v81, 7, v3
    ds_read_b32 v81, v81
    v_lshl_add_u32 v82, v82, 7, v4
    ds_read_b32 v82, v82
    buffer_load_dwordx4 v[132:135], v2, s[12:15], s24 offen
    s_add_u32 s24, s24, 18432
    v_lshl_add_u32 v83, v83, 7, v4
    ds_read_b32 v83, v83
    v_lshl_add_u32 v84, v84, 7, v3
    ds_read_b32 v84, v84
    v_lshl_add_u32 v85, v85, 7, v3
    ds_read_b32 v85, v85
    buffer_load_dwordx4 v[136:139], v2, s[12:15], s24 offen
    s_add_u32 s24, s24, 18432
    v_lshl_add_u32 v86, v86, 7, v4
    ds_read_b32 v86, v86
    v_lshl_add_u32 v87, v87, 7, v4
    ds_read_b32 v87, v87
    buffer_load_dwordx4 v[140:143], v2, s[12:15], s24 offen
    s_add_u32 s24, s24, 18432
    s_waitcnt lgkmcnt(8)
    v_perm_b32 v10, v76, v72, s36
    v_perm_b32 v14, v77, v73, s37
    v_perm_b32 v18, v78, v74, s36
    buffer_load_dwordx4 v[144:147], v2, s[12:15], s24 offen
    s_add_u32 s24, s24, 18432
    v_perm_b32 v22, v79, v75, s37
    s_waitcnt lgkmcnt(0)
    v_perm_b32 v11, v84, v80, s36
    ds_write_b128 v5, v[8:11] offset:16384
    v_perm_b32 v15, v85, v81, s37
    ds_write_b128 v5, v[12:15] offset:17408
    buffer_load_dwordx4 v[148:151], v2, s[12:15], s24 offen
    s_add_u32 s24, s24, 1050624
    v_perm_b32 v19, v86, v82, s36
    ds_write_b128 v6, v[16:19] offset:16384
    v_perm_b32 v23, v87, v83, s37
    ds_write_b128 v6, v[20:23] offset:17408
    s_waitcnt vmcnt(25)
    s_waitcnt lgkmcnt(0)
    s_barrier
    s_add_u32 m0, s35, 38912
    s_nop 0
    buffer_load_dwordx4 v1, s[8:11], s25 offen  lds
    s_add_u32 s25, s25, 36864
    s_waitcnt vmcnt(24)
    v_lshl_add_u32 v88, v88, 7, v3
    ds_read_b32 v88, v88
    v_lshl_add_u32 v89, v89, 7, v3
    ds_read_b32 v89, v89
    v_lshl_add_u32 v90, v90, 7, v4
    ds_read_b32 v90, v90
    s_add_u32 m0, s35, 43008
    s_nop 0
    buffer_load_dwordx4 v1, s[8:11], s25 offen  lds
    s_add_u32 s25, s25, 36864
    v_lshl_add_u32 v91, v91, 7, v4
    ds_read_b32 v91, v91
    v_lshl_add_u32 v92, v92, 7, v3
    ds_read_b32 v92, v92
    v_lshl_add_u32 v93, v93, 7, v3
    ds_read_b32 v93, v93
    s_add_u32 m0, s35, 47104
    s_nop 0
    buffer_load_dwordx4 v1, s[8:11], s25 offen  lds
    s_add_u32 s25, s25, 36864
    v_lshl_add_u32 v94, v94, 7, v4
    ds_read_b32 v94, v94
    v_lshl_add_u32 v95, v95, 7, v4
    ds_read_b32 v95, v95
    s_add_u32 m0, s35, 51200
    s_nop 0
    buffer_load_dwordx4 v1, s[8:11], s25 offen  lds
    s_add_u32 s25, s25, 36864
    s_waitcnt vmcnt(25)
    v_lshl_add_u32 v96, v96, 7, v3
    ds_read_b32 v96, v96
    v_lshl_add_u32 v97, v97, 7, v3
    ds_read_b32 v97, v97
    v_lshl_add_u32 v98, v98, 7, v4
    ds_read_b32 v98, v98
    s_add_u32 m0, s35, 55296
    s_nop 0
    buffer_load_dwordx4 v1, s[8:11], s25 offen  lds
    s_add_u32 s25, s25, 36864
    v_lshl_add_u32 v99, v99, 7, v4
    ds_read_b32 v99, v99
    v_lshl_add_u32 v100, v100, 7, v3
    ds_read_b32 v100, v100
    v_lshl_add_u32 v101, v101, 7, v3
    ds_read_b32 v101, v101
    s_add_u32 m0, s35, 59392
    s_nop 0
    buffer_load_dwordx4 v1, s[8:11], s25 offen  lds
    s_add_u32 s25, s25, 36864
    v_lshl_add_u32 v102, v102, 7, v4
    ds_read_b32 v102, v102
    v_lshl_add_u32 v103, v103, 7, v4
    ds_read_b32 v103, v103
    s_add_u32 m0, s35, 63488
    s_nop 0
    buffer_load_dwordx4 v1, s[8:11], s25 offen  lds
    s_add_u32 s25, s25, 36864
    s_waitcnt lgkmcnt(8)
    v_perm_b32 v8, v92, v88, s36
    v_perm_b32 v12, v93, v89, s37
    v_perm_b32 v16, v94, v90, s36
    s_add_u32 m0, s35, 67584
    s_nop 0
    buffer_load_dwordx4 v1, s[8:11], s25 offen  lds
    s_add_u32 s25, s25, 36864
    v_perm_b32 v20, v95, v91, s37
    s_waitcnt vmcnt(27)
    v_lshl_add_u32 v104, v104, 7, v3
    ds_read_b32 v104, v104
    v_lshl_add_u32 v105, v105, 7, v3
    ds_read_b32 v105, v105
    s_add_u32 m0, s35, 71680
    s_nop 0
    buffer_load_dwordx4 v1, s[8:11], s25 offen  lds
    s_add_u32 s25, s25, 36864
    v_lshl_add_u32 v106, v106, 7, v4
    ds_read_b32 v106, v106
    v_lshl_add_u32 v107, v107, 7, v4
    ds_read_b32 v107, v107
    s_add_u32 m0, s35, 75776
    s_mov_b64 exec, s[38:39]
    buffer_load_dwordx4 v1, s[8:11], s25 offen  lds
    s_mov_b64 exec, -1
    s_sub_u32 s25, s25, 331648
    v_lshl_add_u32 v108, v108, 7, v3
    ds_read_b32 v108, v108
    v_lshl_add_u32 v109, v109, 7, v3
    ds_read_b32 v109, v109
    v_lshl_add_u32 v110, v110, 7, v4
    ds_read_b32 v110, v110
    buffer_load_dwordx4 v[24:27], v2, s[12:15], s24 offen
    s_add_u32 s24, s24, 18432
    v_lshl_add_u32 v111, v111, 7, v4
    ds_read_b32 v111, v111
    s_waitcnt lgkmcnt(8)
    v_perm_b32 v9, v100, v96, s36
    v_perm_b32 v13, v101, v97, s37
    buffer_load_dwordx4 v[28:31], v2, s[12:15], s24 offen
    s_add_u32 s24, s24, 18432
    v_perm_b32 v17, v102, v98, s36
    v_perm_b32 v21, v103, v99, s37
    buffer_load_dwordx4 v[32:35], v2, s[12:15], s24 offen
    s_add_u32 s24, s24, 18432
    s_waitcnt vmcnt(29)
    v_lshl_add_u32 v112, v112, 7, v3
    ds_read_b32 v112, v112
    v_lshl_add_u32 v113, v113, 7, v3
    ds_read_b32 v113, v113
    v_lshl_add_u32 v114, v114, 7, v4
    ds_read_b32 v114, v114
    buffer_load_dwordx4 v[36:39], v2, s[12:15], s24 offen
    s_add_u32 s24, s24, 18432
    v_lshl_add_u32 v115, v115, 7, v4
    ds_read_b32 v115, v115
    v_lshl_add_u32 v116, v116, 7, v3
    ds_read_b32 v116, v116
    v_lshl_add_u32 v117, v117, 7, v3
    ds_read_b32 v117, v117
    buffer_load_dwordx4 v[40:43], v2, s[12:15], s24 offen
    s_add_u32 s24, s24, 18432
    v_lshl_add_u32 v118, v118, 7, v4
    ds_read_b32 v118, v118
    v_lshl_add_u32 v119, v119, 7, v4
    ds_read_b32 v119, v119
    buffer_load_dwordx4 v[44:47], v2, s[12:15], s24 offen
    s_add_u32 s24, s24, 18432
    s_waitcnt lgkmcnt(8)
    v_perm_b32 v10, v108, v104, s36
    v_perm_b32 v14, v109, v105, s37
    v_perm_b32 v18, v110, v106, s36
    buffer_load_dwordx4 v[48:51], v2, s[12:15], s24 offen
    s_add_u32 s24, s24, 18432
    v_perm_b32 v22, v111, v107, s37
    s_waitcnt lgkmcnt(0)
    v_perm_b32 v11, v116, v112, s36
    ds_write_b128 v5, v[8:11] offset:0
    v_perm_b32 v15, v117, v113, s37
    ds_write_b128 v5, v[12:15] offset:1024
    buffer_load_dwordx4 v[52:55], v2, s[12:15], s24 offen
    s_add_u32 s24, s24, 1050624
    v_perm_b32 v19, v118, v114, s36
    ds_write_b128 v6, v[16:19] offset:0
    v_perm_b32 v23, v119, v115, s37
    ds_write_b128 v6, v[20:23] offset:1024
    s_waitcnt vmcnt(25)
    s_waitcnt lgkmcnt(0)
    s_barrier
    s_add_u32 m0, s35, 77824
    s_nop 0
    buffer_load_dwordx4 v1, s[8:11], s25 offen  lds
    s_add_u32 s25, s25, 36864
    s_waitcnt vmcnt(24)
    v_lshl_add_u32 v120, v120, 7, v3
    ds_read_b32 v120, v120
    v_lshl_add_u32 v121, v121, 7, v3
    ds_read_b32 v121, v121
    v_lshl_add_u32 v122, v122, 7, v4
    ds_read_b32 v122, v122
    v_lshl_add_u32 v123, v123, 7, v4
    ds_read_b32 v123, v123
    v_lshl_add_u32 v124, v124, 7, v3
    ds_read_b32 v124, v124
    s_add_u32 m0, s35, 81920
    s_nop 0
    buffer_load_dwordx4 v1, s[8:11], s25 offen  lds
    s_add_u32 s25, s25, 36864
    v_lshl_add_u32 v125, v125, 7, v3
    ds_read_b32 v125, v125
    v_lshl_add_u32 v126, v126, 7, v4
    ds_read_b32 v126, v126
    v_lshl_add_u32 v127, v127, 7, v4
    ds_read_b32 v127, v127
    s_waitcnt vmcnt(23)
    v_lshl_add_u32 v128, v128, 7, v3
    ds_read_b32 v128, v128
    v_lshl_add_u32 v129, v129, 7, v3
    ds_read_b32 v129, v129
    s_add_u32 m0, s35, 86016
    s_nop 0
    buffer_load_dwordx4 v1, s[8:11], s25 offen  lds
    s_add_u32 s25, s25, 36864
    v_lshl_add_u32 v130, v130, 7, v4
    ds_read_b32 v130, v130
    v_lshl_add_u32 v131, v131, 7, v4
    ds_read_b32 v131, v131
    v_lshl_add_u32 v132, v132, 7, v3
    ds_read_b32 v132, v132
    v_lshl_add_u32 v133, v133, 7, v3
    ds_read_b32 v133, v133
    v_lshl_add_u32 v134, v134, 7, v4
    ds_read_b32 v134, v134
    s_add_u32 m0, s35, 90112
    s_nop 0
    buffer_load_dwordx4 v1, s[8:11], s25 offen  lds
    s_add_u32 s25, s25, 36864
    v_lshl_add_u32 v135, v135, 7, v4
    ds_read_b32 v135, v135
    s_waitcnt lgkmcnt(8)
    v_perm_b32 v8, v124, v120, s36
    v_perm_b32 v12, v125, v121, s37
    v_perm_b32 v16, v126, v122, s36
    v_perm_b32 v20, v127, v123, s37
    s_add_u32 m0, s35, 94208
    s_nop 0
    buffer_load_dwordx4 v1, s[8:11], s25 offen  lds
    s_add_u32 s25, s25, 36864
    s_waitcnt vmcnt(24)
    v_lshl_add_u32 v136, v136, 7, v3
    ds_read_b32 v136, v136
    v_lshl_add_u32 v137, v137, 7, v3
    ds_read_b32 v137, v137
    v_lshl_add_u32 v138, v138, 7, v4
    ds_read_b32 v138, v138
    v_lshl_add_u32 v139, v139, 7, v4
    ds_read_b32 v139, v139
    s_add_u32 m0, s35, 98304
    s_nop 0
    buffer_load_dwordx4 v1, s[8:11], s25 offen  lds
    s_add_u32 s25, s25, 36864
    v_lshl_add_u32 v140, v140, 7, v3
    ds_read_b32 v140, v140
    v_lshl_add_u32 v141, v141, 7, v3
    ds_read_b32 v141, v141
    v_lshl_add_u32 v142, v142, 7, v4
    ds_read_b32 v142, v142
    v_lshl_add_u32 v143, v143, 7, v4
    ds_read_b32 v143, v143
    s_waitcnt lgkmcnt(8)
    v_perm_b32 v9, v132, v128, s36
    s_add_u32 m0, s35, 102400
    s_nop 0
    buffer_load_dwordx4 v1, s[8:11], s25 offen  lds
    s_add_u32 s25, s25, 36864
    v_perm_b32 v13, v133, v129, s37
    v_perm_b32 v17, v134, v130, s36
    v_perm_b32 v21, v135, v131, s37
    s_waitcnt vmcnt(24)
    v_lshl_add_u32 v144, v144, 7, v3
    ds_read_b32 v144, v144
    v_lshl_add_u32 v145, v145, 7, v3
    ds_read_b32 v145, v145
    s_add_u32 m0, s35, 106496
    s_nop 0
    buffer_load_dwordx4 v1, s[8:11], s25 offen  lds
    s_add_u32 s25, s25, 36864
    v_lshl_add_u32 v146, v146, 7, v4
    ds_read_b32 v146, v146
    v_lshl_add_u32 v147, v147, 7, v4
    ds_read_b32 v147, v147
    v_lshl_add_u32 v148, v148, 7, v3
    ds_read_b32 v148, v148
    v_lshl_add_u32 v149, v149, 7, v3
    ds_read_b32 v149, v149
    v_lshl_add_u32 v150, v150, 7, v4
    ds_read_b32 v150, v150
    s_add_u32 m0, s35, 110592
    s_nop 0
    buffer_load_dwordx4 v1, s[8:11], s25 offen  lds
    s_add_u32 s25, s25, 36864
    v_lshl_add_u32 v151, v151, 7, v4
    ds_read_b32 v151, v151
    s_waitcnt lgkmcnt(8)
    v_perm_b32 v10, v140, v136, s36
    v_perm_b32 v14, v141, v137, s37
    v_perm_b32 v18, v142, v138, s36
    v_perm_b32 v22, v143, v139, s37
    s_add_u32 m0, s35, 114688
    s_mov_b64 exec, s[38:39]
    buffer_load_dwordx4 v1, s[8:11], s25 offen  lds
    s_mov_b64 exec, -1
    s_sub_u32 s25, s25, 331648
    s_waitcnt lgkmcnt(0)
    v_perm_b32 v11, v148, v144, s36
    ds_write_b128 v5, v[8:11] offset:16384
    v_perm_b32 v15, v149, v145, s37
    ds_write_b128 v5, v[12:15] offset:17408
    v_perm_b32 v19, v150, v146, s36
    ds_write_b128 v6, v[16:19] offset:16384
    v_perm_b32 v23, v151, v147, s37
    ds_write_b128 v6, v[20:23] offset:17408
    s_waitcnt vmcnt(17)
    s_waitcnt lgkmcnt(0)
    s_barrier
    s_waitcnt vmcnt(15)
    v_lshl_add_u32 v24, v24, 7, v3
    ds_read_b32 v24, v24
    v_lshl_add_u32 v25, v25, 7, v3
    ds_read_b32 v25, v25
    v_lshl_add_u32 v26, v26, 7, v4
    ds_read_b32 v26, v26
    v_lshl_add_u32 v27, v27, 7, v4
    ds_read_b32 v27, v27
    v_lshl_add_u32 v28, v28, 7, v3
    ds_read_b32 v28, v28
    v_lshl_add_u32 v29, v29, 7, v3
    ds_read_b32 v29, v29
    v_lshl_add_u32 v30, v30, 7, v4
    ds_read_b32 v30, v30
    v_lshl_add_u32 v31, v31, 7, v4
    ds_read_b32 v31, v31
    s_waitcnt vmcnt(13)
    v_lshl_add_u32 v32, v32, 7, v3
    ds_read_b32 v32, v32
    v_lshl_add_u32 v33, v33, 7, v3
    ds_read_b32 v33, v33
    v_lshl_add_u32 v34, v34, 7, v4
    ds_read_b32 v34, v34
    v_lshl_add_u32 v35, v35, 7, v4
    ds_read_b32 v35, v35
    v_lshl_add_u32 v36, v36, 7, v3
    ds_read_b32 v36, v36
    v_lshl_add_u32 v37, v37, 7, v3
    ds_read_b32 v37, v37
    v_lshl_add_u32 v38, v38, 7, v4
    ds_read_b32 v38, v38
    v_lshl_add_u32 v39, v39, 7, v4
    ds_read_b32 v39, v39
    s_waitcnt lgkmcnt(8)
    v_perm_b32 v8, v28, v24, s36
    v_perm_b32 v12, v29, v25, s37
    v_perm_b32 v16, v30, v26, s36
    v_perm_b32 v20, v31, v27, s37
    s_waitcnt vmcnt(11)
    v_lshl_add_u32 v40, v40, 7, v3
    ds_read_b32 v40, v40
    v_lshl_add_u32 v41, v41, 7, v3
    ds_read_b32 v41, v41
    v_lshl_add_u32 v42, v42, 7, v4
    ds_read_b32 v42, v42
    v_lshl_add_u32 v43, v43, 7, v4
    ds_read_b32 v43, v43
    v_lshl_add_u32 v44, v44, 7, v3
    ds_read_b32 v44, v44
    v_lshl_add_u32 v45, v45, 7, v3
    ds_read_b32 v45, v45
    v_lshl_add_u32 v46, v46, 7, v4
    ds_read_b32 v46, v46
    v_lshl_add_u32 v47, v47, 7, v4
    ds_read_b32 v47, v47
    s_waitcnt lgkmcnt(8)
    v_perm_b32 v9, v36, v32, s36
    v_perm_b32 v13, v37, v33, s37
    v_perm_b32 v17, v38, v34, s36
    v_perm_b32 v21, v39, v35, s37
    s_waitcnt vmcnt(9)
    v_lshl_add_u32 v48, v48, 7, v3
    ds_read_b32 v48, v48
    v_lshl_add_u32 v49, v49, 7, v3
    ds_read_b32 v49, v49
    v_lshl_add_u32 v50, v50, 7, v4
    ds_read_b32 v50, v50
    v_lshl_add_u32 v51, v51, 7, v4
    ds_read_b32 v51, v51
    v_lshl_add_u32 v52, v52, 7, v3
    ds_read_b32 v52, v52
    v_lshl_add_u32 v53, v53, 7, v3
    ds_read_b32 v53, v53
    v_lshl_add_u32 v54, v54, 7, v4
    ds_read_b32 v54, v54
    v_lshl_add_u32 v55, v55, 7, v4
    ds_read_b32 v55, v55
    s_waitcnt lgkmcnt(8)
    v_perm_b32 v10, v44, v40, s36
    v_perm_b32 v14, v45, v41, s37
    v_perm_b32 v18, v46, v42, s36
    v_perm_b32 v22, v47, v43, s37
    s_waitcnt lgkmcnt(0)
    v_perm_b32 v11, v52, v48, s36
    ds_write_b128 v5, v[8:11] offset:0
    v_perm_b32 v15, v53, v49, s37
    ds_write_b128 v5, v[12:15] offset:1024
    v_perm_b32 v19, v54, v50, s36
    ds_write_b128 v6, v[16:19] offset:0
    v_perm_b32 v23, v55, v51, s37
    ds_write_b128 v6, v[20:23] offset:1024
    s_waitcnt vmcnt(0)
    s_waitcnt lgkmcnt(0)
    s_barrier
    s_endpgm
L_end:
    s_endpgm
.section .rodata,"a"
.p2align 6
.amdhsa_kernel standalone__weight_only_int_squeezellm__prompt_kernel
  .amdhsa_next_free_vgpr 168
  .amdhsa_next_free_sgpr 102
  .amdhsa_accum_offset 168
  .amdhsa_group_segment_fixed_size 0
  .amdhsa_kernarg_size 48
  .amdhsa_user_sgpr_count 2
  .amdhsa_user_sgpr_kernarg_segment_ptr 1
  .amdhsa_system_sgpr_workgroup_id_x 1
.end_amdhsa_kernel
```
